```python
import torch

def _softmax(x, axis=-1):
    return torch.softmax(x, dim=axis)
def _gelu(x):
    return torch.nn.functional.gelu(x, approximate="tanh")
def _silu(x):
    return torch.nn.functional.silu(x)
def _sigmoid(x):
    return torch.sigmoid(x)
def _layernorm(x, axis=-1, eps=1e-5):
    m = x.mean(dim=axis, keepdim=True)
    v = x.var(dim=axis, keepdim=True, unbiased=False)
    return (x - m) / torch.sqrt(v + eps)
def _scatter_add(tgt, idx, src, axis=0):
    return tgt.clone().index_add_(axis, idx, src)
def _segment_sum(src, seg, n):
    out = torch.zeros((n,) + src.shape[1:], dtype=src.dtype)
    return out.index_add_(0, seg, src)
def _pad(x, pw):
    flat = tuple(v for pair in reversed(pw) for v in pair)
    return torch.nn.functional.pad(x, flat)

kernel_name = 'standalone__molecular_angular_dimenet__graph'

def setup_inputs():

    _w = (lambda a: (lambda t: t.to(torch.bfloat16) if t.is_floating_point() else t)(torch.as_tensor(a)))
    N, deg, D = 10000, 16, 128
    n_rbf, L = max(0, 1), max(3, 1)
    E = N * deg
    T = E * deg
    d = torch.abs((lambda *s: torch.randn(*s, dtype=torch.bfloat16) * 0.05)(E)) + 0.5
    theta = torch.abs((lambda *s: torch.randn(*s, dtype=torch.bfloat16) * 0.05)(T)) * 0.8 + 0.1
    return {
        "h": _w((lambda *s: torch.randn(*s, dtype=torch.bfloat16) * 0.05)(E, D)),
        "d": _w(d),
        "theta": _w(theta),
        "idx_kj": _w((lambda lo, hi, *s: torch.randint(lo, hi, s))(0, E, T).to(torch.int64)),
        "idx_ji": _w((lambda lo, hi, *s: torch.randint(lo, hi, s))(0, E, T).to(torch.int64)),
        "freq": _w(torch.arange(1, n_rbf + 1).to(float) * torch.pi / 5.0),
        "ell": _w(torch.arange(1, L + 1).to(float)),
        "w_sbf": _w((lambda *s: torch.randn(*s, dtype=torch.bfloat16) * 0.05)(n_rbf * L, D) * (n_rbf * L) ** -0.5),
        "w_rbf": _w((lambda *s: torch.randn(*s, dtype=torch.bfloat16) * 0.1)(n_rbf, D) * n_rbf ** -0.5),
    }

def reference(h, d, theta, idx_kj, idx_ji, freq, ell, w_sbf, w_rbf):
    E = h.shape[0]
    n_rbf = freq.shape[0]
    L = ell.shape[0]
    rbf = torch.sin(d[:, None] * freq[None, :]) / d[:, None]
    d_kj = d[idx_kj]
    rad = torch.sin(d_kj[:, None] * freq[None, :]) / d_kj[:, None]
    ang = torch.cos(theta[:, None] * ell[None, :])
    sbf = torch.reshape(rad[:, :, None] * ang[:, None, :], (-1, n_rbf * L))
    m = h[idx_kj] * (sbf @ w_sbf)
    agg = _segment_sum(m, idx_ji, E)
    return h * (rbf @ w_rbf) + agg
```

```asm
; @launch kernel=dn_part_kernel grid=(250,1,1) block=(1024,1,1) lds=67584
; @launch kernel=standalone__molecular_angular_dimenet__graph_kernel grid=(256,1,1) block=(512,1,1) lds=160832
.amdgcn_target "amdgcn-amd-amdhsa--gfx950"
.text
.globl dn_part_kernel
.p2align 8
.type dn_part_kernel,@function
dn_part_kernel:
    s_cmp_ge_u32 s2, 250
    s_cbranch_scc1 LP_end
    s_load_dwordx8 s[12:19], s[0:1], 8
    s_load_dwordx2 s[20:21], s[0:1], 40
    s_load_dwordx2 s[22:23], s[0:1], 88
    s_load_dwordx2 s[26:27], s[0:1], 0
    v_lshlrev_b32 v1, 4, v0
    v_lshlrev_b32 v2, 3, v0
    v_lshlrev_b32 v3, 2, v0
    v_lshlrev_b32 v34, 1, v0
    v_mov_b32 v35, 0
    ds_write_b32 v3, v35
    v_lshrrev_b32 v35, 6, v0
    s_mul_i32 s4, s2, 40960
    s_mul_i32 s5, s2, 20480
    s_mul_i32 s6, s2, 62976
    v_readfirstlane_b32 s3, v35
    s_mul_i32 s7, s2, 1280
    s_lshl_b32 s8, s2, 10
    s_mov_b32 s9, 16384
    s_mov_b32 s10, 32768
    s_mov_b32 s11, 8192
    v_cmp_gt_u32 vcc, 1024, v0
    s_waitcnt lgkmcnt(0)
    s_load_dword s24, s[20:21], 0
    s_add_u32 s28, s18, s4
    s_addc_u32 s29, s19, 0
    s_mov_b32 s30, 40960
    s_mov_b32 s31, 0x20000
    s_mov_b64 exec, vcc
    buffer_load_dwordx4 v[4:7], v1, s[28:31], 0 offen nt
    buffer_load_dwordx4 v[8:11], v1, s[28:31], s9 offen nt
    buffer_load_dwordx2 v[12:13], v2, s[28:31], s10 offen nt
    s_add_u32 s32, s16, s4
    s_addc_u32 s33, s17, 0
    s_mov_b32 s34, 40960
    s_mov_b32 s35, 0x20000
    s_add_u32 s36, s14, s5
    s_addc_u32 s37, s15, 0
    s_mov_b32 s38, 20480
    s_mov_b32 s39, 0x20000
    s_add_u32 s48, s12, s7
    s_addc_u32 s49, s13, 0
    s_mov_b32 s50, 1280
    s_mov_b32 s51, 0x20000
    s_add_u32 s40, s22, s6
    s_addc_u32 s41, s23, 0
    s_mov_b32 s42, 62976
    s_mov_b32 s43, 0x20000
    s_add_u32 s8, s8, 15744000
    s_add_u32 s44, s22, s8
    s_addc_u32 s45, s23, 0
    s_mov_b32 s46, 1024
    s_mov_b32 s47, 0x20000
    s_add_u32 s7, s7, 16268288
    s_add_u32 s52, s22, s7
    s_addc_u32 s53, s23, 0
    s_mov_b32 s54, 1280
    s_mov_b32 s55, 0x20000
    s_add_u32 s7, s7, 320000
    s_add_u32 s64, s22, s7
    s_addc_u32 s65, s23, 0
    s_mov_b32 s66, 1280
    s_mov_b32 s67, 0x20000
    s_mov_b32 s25, 0x380
    s_mov_b32 s61, 0xf8
    v_mov_b32 v35, 4
    s_barrier
    s_waitcnt vmcnt(0)
    buffer_load_ushort v33, v34, s[48:51], 0 offen
    buffer_load_dwordx4 v[16:19], v1, s[32:35], 0 offen nt
    buffer_load_dwordx2 v[28:29], v2, s[36:39], 0 offen nt
    buffer_load_dwordx4 v[20:23], v1, s[32:35], s9 offen nt
    buffer_load_dwordx2 v[30:31], v2, s[36:39], s11 offen nt
    buffer_load_dwordx2 v[24:25], v2, s[32:35], s10 offen nt
    buffer_load_dword v32, v3, s[36:39], s9 offen nt
    s_waitcnt vmcnt(9)
    v_lshlrev_b32 v36, 2, v4
    v_lshrrev_b32 v56, 6, v4
    v_bfi_b32 v56, s25, v36, v56
    v_and_b32 v56, 0x3fc, v56
    ds_add_rtn_u32 v66, v56, v35 offset:0
    v_lshlrev_b32 v37, 2, v5
    v_lshrrev_b32 v57, 6, v5
    v_bfi_b32 v57, s25, v37, v57
    v_and_b32 v57, 0x3fc, v57
    ds_add_rtn_u32 v67, v57, v35 offset:0
    v_lshlrev_b32 v38, 2, v6
    v_lshrrev_b32 v58, 6, v6
    v_bfi_b32 v58, s25, v38, v58
    v_and_b32 v58, 0x3fc, v58
    ds_add_rtn_u32 v68, v58, v35 offset:0
    v_lshlrev_b32 v39, 2, v7
    v_lshrrev_b32 v59, 6, v7
    v_bfi_b32 v59, s25, v39, v59
    v_and_b32 v59, 0x3fc, v59
    ds_add_rtn_u32 v69, v59, v35 offset:0
    s_waitcnt vmcnt(8)
    v_lshlrev_b32 v40, 2, v8
    v_lshrrev_b32 v60, 6, v8
    v_bfi_b32 v60, s25, v40, v60
    v_and_b32 v60, 0x3fc, v60
    ds_add_rtn_u32 v70, v60, v35 offset:0
    v_lshlrev_b32 v41, 2, v9
    v_lshrrev_b32 v61, 6, v9
    v_bfi_b32 v61, s25, v41, v61
    v_and_b32 v61, 0x3fc, v61
    ds_add_rtn_u32 v71, v61, v35 offset:0
    v_lshlrev_b32 v42, 2, v10
    v_lshrrev_b32 v62, 6, v10
    v_bfi_b32 v62, s25, v42, v62
    v_and_b32 v62, 0x3fc, v62
    ds_add_rtn_u32 v72, v62, v35 offset:0
    v_lshlrev_b32 v43, 2, v11
    v_lshrrev_b32 v63, 6, v11
    v_bfi_b32 v63, s25, v43, v63
    v_and_b32 v63, 0x3fc, v63
    ds_add_rtn_u32 v73, v63, v35 offset:0
    s_waitcnt vmcnt(7)
    v_lshlrev_b32 v44, 2, v12
    v_lshrrev_b32 v64, 6, v12
    v_bfi_b32 v64, s25, v44, v64
    v_and_b32 v64, 0x3fc, v64
    ds_add_rtn_u32 v74, v64, v35 offset:0
    v_lshlrev_b32 v45, 2, v13
    v_lshrrev_b32 v65, 6, v13
    v_bfi_b32 v65, s25, v45, v65
    v_and_b32 v65, 0x3fc, v65
    ds_add_rtn_u32 v75, v65, v35 offset:0
    v_lshl_add_u32 v36, v4, 23, v4
    v_lshrrev_b32 v4, 10, v4
    v_add_u32 v36, v36, v36
    v_and_b32 v36, 0x1c000006, v36
    v_and_or_b32 v36, v4, s61, v36
    v_lshl_add_u32 v37, v5, 23, v5
    v_lshrrev_b32 v5, 10, v5
    v_add_u32 v37, v37, v37
    v_and_b32 v37, 0x1c000006, v37
    v_and_or_b32 v37, v5, s61, v37
    v_lshl_add_u32 v38, v6, 23, v6
    v_lshrrev_b32 v6, 10, v6
    v_add_u32 v38, v38, v38
    v_and_b32 v38, 0x1c000006, v38
    v_and_or_b32 v38, v6, s61, v38
    v_lshl_add_u32 v39, v7, 23, v7
    v_lshrrev_b32 v7, 10, v7
    v_add_u32 v39, v39, v39
    v_and_b32 v39, 0x1c000006, v39
    v_and_or_b32 v39, v7, s61, v39
    v_lshl_add_u32 v40, v8, 23, v8
    v_lshrrev_b32 v8, 10, v8
    v_add_u32 v40, v40, v40
    v_and_b32 v40, 0x1c000006, v40
    v_and_or_b32 v40, v8, s61, v40
    v_lshl_add_u32 v41, v9, 23, v9
    v_lshrrev_b32 v9, 10, v9
    v_add_u32 v41, v41, v41
    v_and_b32 v41, 0x1c000006, v41
    v_and_or_b32 v41, v9, s61, v41
    v_lshl_add_u32 v42, v10, 23, v10
    v_lshrrev_b32 v10, 10, v10
    v_add_u32 v42, v42, v42
    v_and_b32 v42, 0x1c000006, v42
    v_and_or_b32 v42, v10, s61, v42
    v_lshl_add_u32 v43, v11, 23, v11
    v_lshrrev_b32 v11, 10, v11
    v_add_u32 v43, v43, v43
    v_and_b32 v43, 0x1c000006, v43
    v_and_or_b32 v43, v11, s61, v43
    v_lshl_add_u32 v44, v12, 23, v12
    v_lshrrev_b32 v12, 10, v12
    v_add_u32 v44, v44, v44
    v_and_b32 v44, 0x1c000006, v44
    v_and_or_b32 v44, v12, s61, v44
    v_lshl_add_u32 v45, v13, 23, v13
    v_lshrrev_b32 v13, 10, v13
    v_add_u32 v45, v45, v45
    v_and_b32 v45, 0x1c000006, v45
    v_and_or_b32 v45, v13, s61, v45
    s_waitcnt lgkmcnt(0)
    s_barrier
    v_and_b32 v88, 63, v0
    v_lshlrev_b32 v88, 4, v88
    s_cmp_lg_u32 s3, 0
    s_cbranch_scc1 LP_noscan
    s_setprio 3
    ds_read_b128 v[76:79], v88 offset:0
    s_waitcnt lgkmcnt(0)
    v_add_u32 v84, 4, v76
    v_and_b32 v84, -8, v84
    v_add_u32 v85, 4, v77
    v_and_b32 v85, -8, v85
    v_add_u32 v86, 4, v78
    v_and_b32 v86, -8, v86
    v_add_u32 v87, 4, v79
    v_and_b32 v87, -8, v87
    v_add_u32 v85, v84, v85
    v_add_u32 v86, v85, v86
    v_add_u32 v87, v86, v87
    v_mov_b32 v89, v87
    s_nop 1
    v_add_u32_dpp v89, v89, v89 row_shr:1 row_mask:0xf bank_mask:0xf
    s_nop 1
    v_add_u32_dpp v89, v89, v89 row_shr:2 row_mask:0xf bank_mask:0xf
    s_nop 1
    v_add_u32_dpp v89, v89, v89 row_shr:4 row_mask:0xf bank_mask:0xf
    s_nop 1
    v_add_u32_dpp v89, v89, v89 row_shr:8 row_mask:0xf bank_mask:0xf
    s_nop 1
    v_add_u32_dpp v89, v89, v89 row_bcast:15 row_mask:0xa bank_mask:0xf
    s_nop 1
    v_add_u32_dpp v89, v89, v89 row_bcast:31 row_mask:0xc bank_mask:0xf
    v_sub_u32 v80, v89, v87
    v_add_u32 v81, v80, v84
    v_add_u32 v82, v80, v85
    v_add_u32 v83, v80, v86
    ds_write_b128 v88, v[80:83] offset:1024
    v_add_u32 v76, v76, v80
    v_lshrrev_b32 v80, 2, v80
    v_lshl_or_b32 v76, v76, 14, v80
    v_add_u32 v77, v77, v81
    v_lshrrev_b32 v81, 2, v81
    v_lshl_or_b32 v77, v77, 14, v81
    v_add_u32 v78, v78, v82
    v_lshrrev_b32 v82, 2, v82
    v_lshl_or_b32 v78, v78, 14, v82
    v_add_u32 v79, v79, v83
    v_lshrrev_b32 v83, 2, v83
    v_lshl_or_b32 v79, v79, 14, v83
LP_noscan:
    s_waitcnt lgkmcnt(0)
    s_barrier
    s_setprio 0
    ds_read_b32 v56, v56 offset:1024
    ds_read_b32 v57, v57 offset:1024
    ds_read_b32 v58, v58 offset:1024
    ds_read_b32 v59, v59 offset:1024
    ds_read_b32 v60, v60 offset:1024
    ds_read_b32 v61, v61 offset:1024
    ds_read_b32 v62, v62 offset:1024
    ds_read_b32 v63, v63 offset:1024
    ds_read_b32 v64, v64 offset:1024
    ds_read_b32 v65, v65 offset:1024
    s_waitcnt lgkmcnt(9)
    v_add_u32 v56, v56, v66
    v_lshrrev_b32 v66, 1, v56
    s_waitcnt lgkmcnt(8)
    v_add_u32 v57, v57, v67
    v_lshrrev_b32 v67, 1, v57
    s_waitcnt lgkmcnt(7)
    v_add_u32 v58, v58, v68
    v_lshrrev_b32 v68, 1, v58
    s_waitcnt lgkmcnt(6)
    v_add_u32 v59, v59, v69
    v_lshrrev_b32 v69, 1, v59
    s_waitcnt lgkmcnt(5)
    v_add_u32 v60, v60, v70
    v_lshrrev_b32 v70, 1, v60
    s_waitcnt lgkmcnt(4)
    v_add_u32 v61, v61, v71
    v_lshrrev_b32 v71, 1, v61
    s_waitcnt lgkmcnt(3)
    v_add_u32 v62, v62, v72
    v_lshrrev_b32 v72, 1, v62
    s_waitcnt lgkmcnt(2)
    v_add_u32 v63, v63, v73
    v_lshrrev_b32 v73, 1, v63
    s_waitcnt lgkmcnt(1)
    v_add_u32 v64, v64, v74
    v_lshrrev_b32 v74, 1, v64
    s_waitcnt lgkmcnt(0)
    v_add_u32 v65, v65, v75
    v_lshrrev_b32 v75, 1, v65
    s_waitcnt vmcnt(4)
    v_lshl_or_b32 v16, v16, 8, v36
    ds_write_b32 v56, v16 offset:2048
    ds_write_b16 v66, v28 offset:44032
    v_lshl_or_b32 v17, v17, 8, v37
    ds_write_b32 v57, v17 offset:2048
    ds_write_b16_d16_hi v67, v28 offset:44032
    v_lshl_or_b32 v18, v18, 8, v38
    ds_write_b32 v58, v18 offset:2048
    ds_write_b16 v68, v29 offset:44032
    v_lshl_or_b32 v19, v19, 8, v39
    ds_write_b32 v59, v19 offset:2048
    ds_write_b16_d16_hi v69, v29 offset:44032
    s_waitcnt vmcnt(2)
    v_lshl_or_b32 v20, v20, 8, v40
    ds_write_b32 v60, v20 offset:2048
    ds_write_b16 v70, v30 offset:44032
    v_lshl_or_b32 v21, v21, 8, v41
    ds_write_b32 v61, v21 offset:2048
    ds_write_b16_d16_hi v71, v30 offset:44032
    v_lshl_or_b32 v22, v22, 8, v42
    ds_write_b32 v62, v22 offset:2048
    ds_write_b16 v72, v31 offset:44032
    v_lshl_or_b32 v23, v23, 8, v43
    ds_write_b32 v63, v23 offset:2048
    ds_write_b16_d16_hi v73, v31 offset:44032
    s_waitcnt vmcnt(0)
    v_lshl_or_b32 v24, v24, 8, v44
    ds_write_b32 v64, v24 offset:2048
    ds_write_b16 v74, v32 offset:44032
    v_lshl_or_b32 v25, v25, 8, v45
    ds_write_b32 v65, v25 offset:2048
    ds_write_b16_d16_hi v75, v32 offset:44032
    s_lshl_b32 s24, s24, 16
    v_lshlrev_b32 v33, 16, v33
    v_mul_f32 v84, s24, v33
    v_cvt_pk_bf16_f32 v84, v84, v84
    v_lshlrev_b32 v84, 16, v84
    v_mul_f32 v85, 0x3e22f900, v84
    v_fract_f32 v85, v85
    v_fmac_f32 v85, 0x36036e4e, v84
    v_sin_f32 v85, v85
    v_rcp_f32 v33, v33
    v_cvt_pk_bf16_f32 v85, v85, v85
    v_lshlrev_b32 v85, 16, v85
    v_mul_f32 v85, v85, v33
    v_cvt_pk_bf16_f32 v85, v85, v85
    buffer_store_short v85, v34, s[52:55], 0 offen sc1
    buffer_store_short v85, v34, s[64:67], 0 offen sc1
    s_cmp_lg_u32 s3, 0
    s_cbranch_scc1 LP_nooff
    buffer_store_dwordx4 v[76:79], v88, s[44:47], 0 offen sc1
LP_nooff:
    s_mov_b64 exec, -1
    v_add_u32 v2, 16384, v1
    v_add_u32 v3, 32768, v1
    v_add_u32 v34, 49152, v1
    s_waitcnt lgkmcnt(0)
    s_barrier
    ds_read_b128 v[4:7], v1 offset:2048
    ds_read_b128 v[8:11], v1 offset:18432
    ds_read_b128 v[12:15], v1 offset:34816
    ds_read_b128 v[16:19], v1 offset:51200
    s_waitcnt lgkmcnt(3)
    buffer_store_dwordx4 v[4:7], v1, s[40:43], 0 offen sc1
    s_waitcnt lgkmcnt(2)
    buffer_store_dwordx4 v[8:11], v2, s[40:43], 0 offen sc1
    s_waitcnt lgkmcnt(1)
    buffer_store_dwordx4 v[12:15], v3, s[40:43], 0 offen sc1
    s_waitcnt lgkmcnt(0)
    buffer_store_dwordx4 v[16:19], v34, s[40:43], 0 offen sc1
LP_end:
    s_endpgm
.globl standalone__molecular_angular_dimenet__graph_kernel
.p2align 8
.type standalone__molecular_angular_dimenet__graph_kernel,@function
standalone__molecular_angular_dimenet__graph_kernel:
    s_cmp_ge_u32 s2, 256
    s_cbranch_scc1 LM_end
    s_load_dwordx2 s[4:5], s[0:1], 0
    s_load_dwordx2 s[6:7], s[0:1], 88
    s_load_dwordx4 s[40:43], s[0:1], 56
    s_load_dwordx2 s[44:45], s[0:1], 48
    v_lshrrev_b32 v160, 6, v0
    v_and_b32 v254, 63, v0
    v_lshlrev_b32 v161, 2, v0
    v_readfirstlane_b32 s3, v160
    v_mov_b32 v162, 0
    ds_write_b32 v161, v162 offset:9216
    ds_write_b32 v161, v162 offset:11264
    ds_write_b32 v161, v162 offset:0
    s_and_b32 s33, s2, 7
    s_lshr_b32 s34, s2, 3
    s_lshl_b32 s100, s34, 13
    s_getreg_b32 s101, hwreg(HW_REG_XCC_ID, 0, 3)
    s_mul_i32 s101, s101, 10
    s_lshl_b32 s33, s33, 5
    s_add_u32 s34, s34, s33
    v_and_b32 v163, 15, v254
    v_lshlrev_b32 v250, 4, v163
    v_lshrrev_b32 v164, 5, v254
    v_lshrrev_b32 v171, 4, v254
    v_and_b32 v165, 7, v254
    v_lshl_add_u32 v165, v165, 2, v171
    s_lshl_b32 s33, s3, 15
    s_lshl_b32 s34, s34, 2
    s_add_u32 s33, s33, s34
    v_lshl_add_u32 v166, v165, 10, s33
    s_waitcnt lgkmcnt(0)
    s_add_u32 s24, s6, 15744000
    s_addc_u32 s25, s7, 0
    s_mov_b32 s26, 256000
    s_mov_b32 s27, 0x20000
    buffer_load_dword v255, v166, s[24:27], 0 offen
    s_mov_b32 s8, s4
    s_mov_b32 s9, s5
    s_mov_b32 s10, 40960000
    s_mov_b32 s11, 0x20000
    s_mov_b32 s16, s6
    s_mov_b32 s17, s7
    s_mov_b32 s18, 15744000
    s_mov_b32 s19, 0x20000
    s_add_u32 s20, s6, 16268288
    s_addc_u32 s21, s7, 0
    s_mov_b32 s22, 742400
    s_mov_b32 s23, 0x20000
    v_lshlrev_b32 v247, 4, v254
    s_mul_i32 s5, s101, 524288
    s_lshl_b32 s4, s3, 10
    s_add_u32 s4, s4, s5
    s_add_u32 s100, s4, s100
    s_load_dwordx2 s[30:31], s[44:45], 0
    s_mov_b32 s12, s40
    s_mov_b32 s13, s41
    s_mov_b32 s14, 768
    s_mov_b32 s15, 0x20000
    s_mov_b32 s36, s42
    s_mov_b32 s37, s43
    s_mov_b32 s38, 256
    s_mov_b32 s39, 0x20000
    v_bfe_u32 v167, v254, 4, 1
    v_lshl_add_u32 v167, v167, 1, v164
    v_lshl_add_u32 v167, v167, 1, v250
    buffer_load_ushort v228, v167, s[12:15], 0 offen
    buffer_load_ushort v192, v167, s[12:15], 0 offen offset:256
    buffer_load_ushort v229, v167, s[12:15], 0 offen offset:512
    buffer_load_ushort v193, v167, s[36:39], 0 offen
    buffer_load_ushort v230, v167, s[12:15], 0 offen offset:8
    buffer_load_ushort v194, v167, s[12:15], 0 offen offset:264
    buffer_load_ushort v231, v167, s[12:15], 0 offen offset:520
    buffer_load_ushort v195, v167, s[36:39], 0 offen offset:8
    s_mul_i32 s4, s3, 6656
    s_add_u32 s4, s4, 106560
    v_lshl_add_u32 v251, v254, 4, s4
    v_mov_b32 v224, 0x83ffff00
    v_mov_b32 v225, 0x83ffff00
    v_mov_b32 v226, 0x83ffff00
    v_mov_b32 v227, 0x83ffff00
    ds_write_b128 v251, v[224:227] offset:0
    ds_write_b128 v251, v[224:227] offset:1024
    ds_write_b128 v251, v[224:227] offset:2048
    ds_write_b128 v251, v[224:227] offset:3072
    ds_write_b128 v251, v[224:227] offset:4096
    ds_write_b128 v251, v[224:227] offset:5120
    s_mov_b64 exec, 0xffffffff
    s_mov_b32 exec_hi, 0
    ds_write_b128 v251, v[224:227] offset:6144
    s_mov_b64 exec, -1
    s_mul_i32 s4, s3, 3328
    s_add_u32 s4, s4, 79936
    v_lshl_add_u32 v251, v254, 4, s4
    v_mov_b32 v208, 0x0
    v_mov_b32 v209, 0x0
    v_mov_b32 v210, 0x0
    v_mov_b32 v211, 0x0
    ds_write_b128 v251, v[208:211] offset:0
    ds_write_b128 v251, v[208:211] offset:1024
    ds_write_b128 v251, v[208:211] offset:2048
    s_mov_b64 exec, 0xffff
    ds_write_b128 v251, v[208:211] offset:3072
    s_mov_b64 exec, -1
    v_lshlrev_b32 v174, 2, v163
    v_mul_u32_u24 v175, 62976, v171
    v_add_u32 v173, 41984, v175
    v_mov_b32 v245, 4
    s_mul_i32 s33, s3, 2015232
    s_mov_b32 s35, 0
    s_waitcnt vmcnt(8)
    v_lshrrev_b32 v176, 16, v255
    v_and_b32 v177, 0xffff, v255
    v_sub_u32 v176, v176, v177
    v_cmp_lt_u32 s[4:5], 64, v176
    s_mov_b64 s[12:13], 0
    s_mov_b64 s[14:15], 0
    s_and_b32 s4, s4, 0x00ff00ff
    s_and_b32 s5, s5, 0x00ff00ff
    s_cmp_eq_u64 s[4:5], 0
    s_cbranch_scc1 LM_noextra
    v_mov_b32 v177, 128
    v_cmp_gt_u32 vcc, v176, v177
    s_bcnt1_i32_b64 s6, s[4:5]
    s_cmp_gt_u32 s6, 2
    s_cselect_b32 s35, 1, 0
    s_cmp_lg_u64 vcc, 0
    s_cselect_b32 s35, 1, s35
    s_ff1_i32_b64 s6, s[4:5]
    s_bitset0_b64 s[4:5], s6
    v_readlane_b32 s7, v255, s6
    s_and_b32 s34, s6, 7
    s_lshr_b32 s6, s6, 4
    s_lshl_b32 s34, s34, 2
    s_add_u32 s6, s6, s34
    s_mul_i32 s6, s6, 62976
    s_add_u32 s6, s6, s33
    s_and_b32 s34, s7, 0xffff
    s_lshr_b32 s7, s7, 16
    s_add_u32 s34, s34, 64
    v_add_u32 v177, s34, v254
    v_cmp_gt_u32 s[12:13], s7, v177
    v_lshlrev_b32 v178, 2, v177
    v_lshlrev_b32 v177, 1, v177
    v_add_u32 v177, 41984, v177
    s_mov_b64 exec, s[12:13]
    buffer_load_dword v48, v178, s[16:19], s6 offen
    buffer_load_ushort v49, v177, s[16:19], s6 offen
    s_mov_b64 exec, -1
    s_cmp_eq_u64 s[4:5], 0
    s_cbranch_scc1 LM_noextra
    s_ff1_i32_b64 s6, s[4:5]
    s_bitset0_b64 s[4:5], s6
    v_readlane_b32 s7, v255, s6
    s_and_b32 s34, s6, 7
    s_lshr_b32 s6, s6, 4
    s_lshl_b32 s34, s34, 2
    s_add_u32 s6, s6, s34
    s_mul_i32 s6, s6, 62976
    s_add_u32 s6, s6, s33
    s_and_b32 s34, s7, 0xffff
    s_lshr_b32 s7, s7, 16
    s_add_u32 s34, s34, 64
    v_add_u32 v177, s34, v254
    v_cmp_gt_u32 s[14:15], s7, v177
    v_lshlrev_b32 v178, 2, v177
    v_lshlrev_b32 v177, 1, v177
    v_add_u32 v177, 41984, v177
    s_mov_b64 exec, s[14:15]
    buffer_load_dword v50, v178, s[16:19], s6 offen
    buffer_load_ushort v51, v177, s[16:19], s6 offen
    s_mov_b64 exec, -1
LM_noextra:
    v_mov_b32_dpp v176, v255 row_newbcast:0 row_mask:0xf bank_mask:0xf
    v_lshrrev_b32 v177, 16, v176
    v_and_b32 v176, 0xffff, v176
    v_add_u32 v176, v176, v174
    v_sub_u32 v177, v177, v176
    v_cmp_lt_i32 s[36:37], 0, v177
    v_lshl_add_u32 v178, v176, 1, v173
    v_lshl_add_u32 v176, v176, 2, v175
    v_cmp_lt_i32 s[38:39], 1, v177
    v_cmp_lt_i32 s[40:41], 2, v177
    v_cmp_lt_i32 s[42:43], 3, v177
    s_mov_b64 exec, s[36:37]
    buffer_load_dwordx4 v[0:3], v176, s[16:19], s33 offen
    buffer_load_dwordx2 v[32:33], v178, s[16:19], s33 offen
    s_mov_b64 exec, -1
    s_add_u32 s33, s33, 251904
    v_mov_b32_dpp v179, v255 row_newbcast:1 row_mask:0xf bank_mask:0xf
    v_lshrrev_b32 v180, 16, v179
    v_and_b32 v179, 0xffff, v179
    v_add_u32 v179, v179, v174
    v_sub_u32 v180, v180, v179
    v_cmp_lt_i32 s[44:45], 0, v180
    v_lshl_add_u32 v181, v179, 1, v173
    v_lshl_add_u32 v179, v179, 2, v175
    v_cmp_lt_i32 s[46:47], 1, v180
    v_cmp_lt_i32 s[48:49], 2, v180
    v_cmp_lt_i32 s[50:51], 3, v180
    s_mov_b64 exec, s[44:45]
    buffer_load_dwordx4 v[4:7], v179, s[16:19], s33 offen
    buffer_load_dwordx2 v[34:35], v181, s[16:19], s33 offen
    s_mov_b64 exec, -1
    s_add_u32 s33, s33, 251904
    v_mov_b32_dpp v176, v255 row_newbcast:2 row_mask:0xf bank_mask:0xf
    v_lshrrev_b32 v177, 16, v176
    v_and_b32 v176, 0xffff, v176
    v_add_u32 v176, v176, v174
    v_sub_u32 v177, v177, v176
    v_cmp_lt_i32 s[52:53], 0, v177
    v_lshl_add_u32 v178, v176, 1, v173
    v_lshl_add_u32 v176, v176, 2, v175
    v_cmp_lt_i32 s[54:55], 1, v177
    v_cmp_lt_i32 s[56:57], 2, v177
    v_cmp_lt_i32 s[58:59], 3, v177
    s_mov_b64 exec, s[52:53]
    buffer_load_dwordx4 v[8:11], v176, s[16:19], s33 offen
    buffer_load_dwordx2 v[36:37], v178, s[16:19], s33 offen
    s_mov_b64 exec, -1
    s_add_u32 s33, s33, 251904
    v_mov_b32_dpp v179, v255 row_newbcast:3 row_mask:0xf bank_mask:0xf
    v_lshrrev_b32 v180, 16, v179
    v_and_b32 v179, 0xffff, v179
    v_add_u32 v179, v179, v174
    v_sub_u32 v180, v180, v179
    v_cmp_lt_i32 s[60:61], 0, v180
    v_lshl_add_u32 v181, v179, 1, v173
    v_lshl_add_u32 v179, v179, 2, v175
    v_cmp_lt_i32 s[62:63], 1, v180
    v_cmp_lt_i32 s[64:65], 2, v180
    v_cmp_lt_i32 s[66:67], 3, v180
    s_mov_b64 exec, s[60:61]
    buffer_load_dwordx4 v[12:15], v179, s[16:19], s33 offen
    buffer_load_dwordx2 v[38:39], v181, s[16:19], s33 offen
    s_mov_b64 exec, -1
    s_add_u32 s33, s33, 251904
    v_mov_b32_dpp v176, v255 row_newbcast:4 row_mask:0xf bank_mask:0xf
    v_lshrrev_b32 v177, 16, v176
    v_and_b32 v176, 0xffff, v176
    v_add_u32 v176, v176, v174
    v_sub_u32 v177, v177, v176
    v_cmp_lt_i32 s[68:69], 0, v177
    v_lshl_add_u32 v178, v176, 1, v173
    v_lshl_add_u32 v176, v176, 2, v175
    v_cmp_lt_i32 s[70:71], 1, v177
    v_cmp_lt_i32 s[72:73], 2, v177
    v_cmp_lt_i32 s[74:75], 3, v177
    s_mov_b64 exec, s[68:69]
    buffer_load_dwordx4 v[16:19], v176, s[16:19], s33 offen
    buffer_load_dwordx2 v[40:41], v178, s[16:19], s33 offen
    s_mov_b64 exec, -1
    s_add_u32 s33, s33, 251904
    v_mov_b32_dpp v179, v255 row_newbcast:5 row_mask:0xf bank_mask:0xf
    v_lshrrev_b32 v180, 16, v179
    v_and_b32 v179, 0xffff, v179
    v_add_u32 v179, v179, v174
    v_sub_u32 v180, v180, v179
    v_cmp_lt_i32 s[76:77], 0, v180
    v_lshl_add_u32 v181, v179, 1, v173
    v_lshl_add_u32 v179, v179, 2, v175
    v_cmp_lt_i32 s[78:79], 1, v180
    v_cmp_lt_i32 s[80:81], 2, v180
    v_cmp_lt_i32 s[82:83], 3, v180
    s_mov_b64 exec, s[76:77]
    buffer_load_dwordx4 v[20:23], v179, s[16:19], s33 offen
    buffer_load_dwordx2 v[42:43], v181, s[16:19], s33 offen
    s_mov_b64 exec, -1
    s_add_u32 s33, s33, 251904
    s_barrier
    s_waitcnt vmcnt(11)
    s_mov_b64 exec, s[36:37]
    v_lshrrev_b32 v58, 17, v0
    v_and_b32 v58, 0xffc, v58
    ds_add_rtn_u32 v94, v58, v245 offset:9216
    s_mov_b64 exec, s[38:39]
    v_lshrrev_b32 v59, 17, v1
    v_and_b32 v59, 0xffc, v59
    ds_add_rtn_u32 v95, v59, v245 offset:9216
    s_mov_b64 exec, s[40:41]
    v_lshrrev_b32 v60, 17, v2
    v_and_b32 v60, 0xffc, v60
    ds_add_rtn_u32 v96, v60, v245 offset:9216
    s_mov_b64 exec, s[42:43]
    v_lshrrev_b32 v61, 17, v3
    v_and_b32 v61, 0xffc, v61
    ds_add_rtn_u32 v97, v61, v245 offset:9216
    s_mov_b64 exec, -1
    v_mov_b32_dpp v176, v255 row_newbcast:6 row_mask:0xf bank_mask:0xf
    v_lshrrev_b32 v177, 16, v176
    v_and_b32 v176, 0xffff, v176
    v_add_u32 v176, v176, v174
    v_sub_u32 v177, v177, v176
    v_cmp_lt_i32 s[84:85], 0, v177
    v_lshl_add_u32 v178, v176, 1, v173
    v_lshl_add_u32 v176, v176, 2, v175
    v_cmp_lt_i32 s[86:87], 1, v177
    v_cmp_lt_i32 s[88:89], 2, v177
    v_cmp_lt_i32 s[90:91], 3, v177
    s_mov_b64 exec, s[84:85]
    buffer_load_dwordx4 v[24:27], v176, s[16:19], s33 offen
    buffer_load_dwordx2 v[44:45], v178, s[16:19], s33 offen
    s_mov_b64 exec, -1
    s_add_u32 s33, s33, 251904
    s_waitcnt vmcnt(11)
    s_mov_b64 exec, s[44:45]
    v_lshrrev_b32 v62, 17, v4
    v_and_b32 v62, 0xffc, v62
    ds_add_rtn_u32 v98, v62, v245 offset:9216
    s_mov_b64 exec, s[46:47]
    v_lshrrev_b32 v63, 17, v5
    v_and_b32 v63, 0xffc, v63
    ds_add_rtn_u32 v99, v63, v245 offset:9216
    s_mov_b64 exec, s[48:49]
    v_lshrrev_b32 v64, 17, v6
    v_and_b32 v64, 0xffc, v64
    ds_add_rtn_u32 v100, v64, v245 offset:9216
    s_mov_b64 exec, s[50:51]
    v_lshrrev_b32 v65, 17, v7
    v_and_b32 v65, 0xffc, v65
    ds_add_rtn_u32 v101, v65, v245 offset:9216
    s_mov_b64 exec, -1
    v_mov_b32_dpp v179, v255 row_newbcast:7 row_mask:0xf bank_mask:0xf
    v_lshrrev_b32 v180, 16, v179
    v_and_b32 v179, 0xffff, v179
    v_add_u32 v179, v179, v174
    v_sub_u32 v180, v180, v179
    v_cmp_lt_i32 s[92:93], 0, v180
    v_lshl_add_u32 v181, v179, 1, v173
    v_lshl_add_u32 v179, v179, 2, v175
    v_cmp_lt_i32 s[94:95], 1, v180
    v_cmp_lt_i32 s[96:97], 2, v180
    v_cmp_lt_i32 s[98:99], 3, v180
    s_mov_b64 exec, s[92:93]
    buffer_load_dwordx4 v[28:31], v179, s[16:19], s33 offen
    buffer_load_dwordx2 v[46:47], v181, s[16:19], s33 offen
    s_mov_b64 exec, -1
    s_add_u32 s33, s33, 251904
    s_waitcnt vmcnt(11)
    s_mov_b64 exec, s[52:53]
    v_lshrrev_b32 v66, 17, v8
    v_and_b32 v66, 0xffc, v66
    ds_add_rtn_u32 v102, v66, v245 offset:9216
    s_mov_b64 exec, s[54:55]
    v_lshrrev_b32 v67, 17, v9
    v_and_b32 v67, 0xffc, v67
    ds_add_rtn_u32 v103, v67, v245 offset:9216
    s_mov_b64 exec, s[56:57]
    v_lshrrev_b32 v68, 17, v10
    v_and_b32 v68, 0xffc, v68
    ds_add_rtn_u32 v104, v68, v245 offset:9216
    s_mov_b64 exec, s[58:59]
    v_lshrrev_b32 v69, 17, v11
    v_and_b32 v69, 0xffc, v69
    ds_add_rtn_u32 v105, v69, v245 offset:9216
    s_mov_b64 exec, -1
    s_lshl_b32 s33, s2, 5
    s_lshl_b32 s34, s3, 2
    s_add_u32 s33, s33, s34
    s_lshl_b32 s34, s3, 26
    s_or_b32 s34, s34, 0xc0000000
    v_mov_b32 v54, 0
    v_add_u32 v251, 0, v254
    v_lshrrev_b32 v252, 2, v251
    v_mul_u32_u24 v252, 8192, v252
    v_and_b32 v52, 3, v251
    v_add3_u32 v252, v252, v52, s33
    v_lshl_or_b32 v52, v252, 7, v251
    v_lshlrev_b32 v52, 1, v52
    v_or_b32 v52, s34, v52
    v_add_u32 v251, 64, v254
    v_lshrrev_b32 v252, 2, v251
    v_mul_u32_u24 v252, 8192, v252
    v_and_b32 v53, 3, v251
    v_add3_u32 v252, v252, v53, s33
    v_lshl_or_b32 v53, v252, 7, v251
    v_lshlrev_b32 v53, 1, v53
    v_or_b32 v53, s34, v53
    s_cmp_lt_u32 s2, 136
    s_cselect_b32 s34, 16, 12
    s_bfm_b32 s34, s34, 0
    s_mov_b64 exec, -1
    v_lshrrev_b32 v56, 17, v52
    v_and_b32 v56, 0xffc, v56
    ds_add_rtn_u32 v92, v56, v245 offset:9216
    s_mov_b32 exec_lo, s34
    s_mov_b32 exec_hi, 0
    v_lshrrev_b32 v57, 17, v53
    v_and_b32 v57, 0xffc, v57
    ds_add_rtn_u32 v93, v57, v245 offset:9216
    s_mov_b64 exec, -1
    s_waitcnt vmcnt(9)
    s_mov_b64 exec, s[60:61]
    v_lshrrev_b32 v70, 17, v12
    v_and_b32 v70, 0xffc, v70
    ds_add_rtn_u32 v106, v70, v245 offset:9216
    s_mov_b64 exec, s[62:63]
    v_lshrrev_b32 v71, 17, v13
    v_and_b32 v71, 0xffc, v71
    ds_add_rtn_u32 v107, v71, v245 offset:9216
    s_mov_b64 exec, s[64:65]
    v_lshrrev_b32 v72, 17, v14
    v_and_b32 v72, 0xffc, v72
    ds_add_rtn_u32 v108, v72, v245 offset:9216
    s_mov_b64 exec, s[66:67]
    v_lshrrev_b32 v73, 17, v15
    v_and_b32 v73, 0xffc, v73
    ds_add_rtn_u32 v109, v73, v245 offset:9216
    s_mov_b64 exec, -1
    s_waitcnt vmcnt(7)
    s_mov_b64 exec, s[68:69]
    v_lshrrev_b32 v74, 17, v16
    v_and_b32 v74, 0xffc, v74
    ds_add_rtn_u32 v110, v74, v245 offset:9216
    s_mov_b64 exec, s[70:71]
    v_lshrrev_b32 v75, 17, v17
    v_and_b32 v75, 0xffc, v75
    ds_add_rtn_u32 v111, v75, v245 offset:9216
    s_mov_b64 exec, s[72:73]
    v_lshrrev_b32 v76, 17, v18
    v_and_b32 v76, 0xffc, v76
    ds_add_rtn_u32 v112, v76, v245 offset:9216
    s_mov_b64 exec, s[74:75]
    v_lshrrev_b32 v77, 17, v19
    v_and_b32 v77, 0xffc, v77
    ds_add_rtn_u32 v113, v77, v245 offset:9216
    s_mov_b64 exec, -1
    s_waitcnt vmcnt(5)
    s_mov_b64 exec, s[76:77]
    v_lshrrev_b32 v78, 17, v20
    v_and_b32 v78, 0xffc, v78
    ds_add_rtn_u32 v114, v78, v245 offset:9216
    s_mov_b64 exec, s[78:79]
    v_lshrrev_b32 v79, 17, v21
    v_and_b32 v79, 0xffc, v79
    ds_add_rtn_u32 v115, v79, v245 offset:9216
    s_mov_b64 exec, s[80:81]
    v_lshrrev_b32 v80, 17, v22
    v_and_b32 v80, 0xffc, v80
    ds_add_rtn_u32 v116, v80, v245 offset:9216
    s_mov_b64 exec, s[82:83]
    v_lshrrev_b32 v81, 17, v23
    v_and_b32 v81, 0xffc, v81
    ds_add_rtn_u32 v117, v81, v245 offset:9216
    s_mov_b64 exec, -1
    s_waitcnt vmcnt(3)
    s_mov_b64 exec, s[84:85]
    v_lshrrev_b32 v82, 17, v24
    v_and_b32 v82, 0xffc, v82
    ds_add_rtn_u32 v118, v82, v245 offset:9216
    s_mov_b64 exec, s[86:87]
    v_lshrrev_b32 v83, 17, v25
    v_and_b32 v83, 0xffc, v83
    ds_add_rtn_u32 v119, v83, v245 offset:9216
    s_mov_b64 exec, s[88:89]
    v_lshrrev_b32 v84, 17, v26
    v_and_b32 v84, 0xffc, v84
    ds_add_rtn_u32 v120, v84, v245 offset:9216
    s_mov_b64 exec, s[90:91]
    v_lshrrev_b32 v85, 17, v27
    v_and_b32 v85, 0xffc, v85
    ds_add_rtn_u32 v121, v85, v245 offset:9216
    s_mov_b64 exec, -1
    s_waitcnt vmcnt(1)
    s_mov_b64 exec, s[92:93]
    v_lshrrev_b32 v86, 17, v28
    v_and_b32 v86, 0xffc, v86
    ds_add_rtn_u32 v122, v86, v245 offset:9216
    s_mov_b64 exec, s[94:95]
    v_lshrrev_b32 v87, 17, v29
    v_and_b32 v87, 0xffc, v87
    ds_add_rtn_u32 v123, v87, v245 offset:9216
    s_mov_b64 exec, s[96:97]
    v_lshrrev_b32 v88, 17, v30
    v_and_b32 v88, 0xffc, v88
    ds_add_rtn_u32 v124, v88, v245 offset:9216
    s_mov_b64 exec, s[98:99]
    v_lshrrev_b32 v89, 17, v31
    v_and_b32 v89, 0xffc, v89
    ds_add_rtn_u32 v125, v89, v245 offset:9216
    s_mov_b64 exec, -1
    s_waitcnt lgkmcnt(0)
    s_lshl_b32 s32, s31, 16
    s_and_b32 s31, s30, 0xffff0000
    s_lshl_b32 s30, s30, 16
    s_mov_b64 exec, s[12:13]
    v_lshrrev_b32 v90, 17, v48
    v_and_b32 v90, 0xffc, v90
    ds_add_rtn_u32 v126, v90, v245 offset:9216
    s_mov_b64 exec, s[14:15]
    v_lshrrev_b32 v91, 17, v50
    v_and_b32 v91, 0xffc, v91
    ds_add_rtn_u32 v127, v91, v245 offset:9216
    s_mov_b64 exec, -1
    s_waitcnt vmcnt(0) lgkmcnt(0)
    s_barrier
    v_lshl_or_b32 v228, v192, 16, v228
    v_lshl_or_b32 v229, v193, 16, v229
    v_lshl_or_b32 v230, v194, 16, v230
    v_lshl_or_b32 v231, v195, 16, v231
    s_lshl_b32 s4, s3, 9
    v_mov_b32 v167, 127
    v_lshl_add_u32 v164, v254, 1, 0
    v_add_u32 v160, s101, v164
    v_subrev_u32 v166, 79, v160
    v_cmp_gt_u32 vcc, 79, v164
    v_min_u32 v160, v160, v166
    s_nop 0
    v_cndmask_b32 v160, v167, v160, vcc
    v_lshl_add_u32 v160, v160, 2, s4
    ds_read_b32 v162, v160 offset:9216
    v_lshl_add_u32 v165, v254, 1, 1
    v_add_u32 v161, s101, v165
    v_subrev_u32 v166, 79, v161
    v_cmp_gt_u32 vcc, 79, v165
    v_min_u32 v161, v161, v166
    s_nop 0
    v_cndmask_b32 v161, v167, v161, vcc
    v_lshl_add_u32 v161, v161, 2, s4
    ds_read_b32 v163, v161 offset:9216
    s_mul_i32 s5, s3, 6656
    s_add_u32 s5, s5, 49152
    s_waitcnt lgkmcnt(0)
    v_add_u32 v163, v162, v163
    v_mov_b32 v166, v163
    s_nop 1
    v_add_u32_dpp v166, v166, v166 row_shr:1 row_mask:0xf bank_mask:0xf
    s_nop 1
    v_add_u32_dpp v166, v166, v166 row_shr:2 row_mask:0xf bank_mask:0xf
    s_nop 1
    v_add_u32_dpp v166, v166, v166 row_shr:4 row_mask:0xf bank_mask:0xf
    s_nop 1
    v_add_u32_dpp v166, v166, v166 row_shr:8 row_mask:0xf bank_mask:0xf
    s_nop 1
    v_add_u32_dpp v166, v166, v166 row_bcast:15 row_mask:0xa bank_mask:0xf
    s_nop 1
    v_add_u32_dpp v166, v166, v166 row_bcast:31 row_mask:0xc bank_mask:0xf
    v_sub_u32 v163, v166, v163
    v_readlane_b32 s29, v166, 63
    v_add_u32 v163, s5, v163
    v_add_u32 v162, v163, v162
    s_lshr_b32 s29, s29, 2
    s_mov_b32 s6, s29
    s_max_u32 s6, s6, 1440
    s_sub_u32 s7, s6, s29
    s_mul_i32 s7, s7, 838
    v_mul_u32_u24 v164, s7, v164
    v_mul_u32_u24 v165, s7, v165
    v_lshrrev_b32 v164, 16, v164
    v_lshrrev_b32 v165, 16, v165
    v_lshl_add_u32 v163, v164, 2, v163
    v_lshl_add_u32 v162, v165, 2, v162
    s_cmp_lg_u32 s35, 0
    s_cselect_b32 s6, 0x7fffffff, s6
    ds_write_b32 v160, v163 offset:9216
    ds_write_b32 v161, v162 offset:9216
    s_lshl_b32 s4, s3, 2
    v_mov_b32 v164, s4
    v_mov_b32 v165, s6
    ds_write_b32 v164, v165 offset:13312
    v_mov_b32 v166, 0
    s_waitcnt lgkmcnt(0)
    s_barrier
    ds_read_b128 v[160:163], v166 offset:13312
    ds_read_b128 v[168:171], v166 offset:13328
    s_waitcnt lgkmcnt(0)
    v_max3_u32 v160, v160, v161, v162
    v_max3_u32 v163, v163, v168, v169
    v_max3_u32 v160, v160, v170, v171
    v_max_u32 v160, v160, v163
    s_nop 0
    v_readfirstlane_b32 s28, v160
    s_cmp_gt_u32 s28, 1664
    s_cbranch_scc1 LM_slow
    s_mul_i32 s6, s101, 4096
    s_mul_i32 s4, s3, 880
    s_add_u32 s6, s6, s4
    s_add_u32 s7, s4, 16448
    s_mov_b64 exec, -1
    ds_read_b32 v56, v56 offset:9216
    s_mov_b32 exec_lo, s34
    s_mov_b32 exec_hi, 0
    ds_read_b32 v57, v57 offset:9216
    s_mov_b64 exec, -1
    v_mov_b32 v55, 0
    v_mov_b32 v128, 0
    v_mov_b32 v129, 0
    v_mov_b32 v130, 0
    v_mov_b32 v131, 0
    v_mov_b32 v132, 0
    v_mov_b32 v133, 0
    v_mov_b32 v134, 0
    v_mov_b32 v135, 0
    v_mov_b32 v136, 0
    s_mov_b32 exec_hi, 0x7fffff
    s_mov_b32 m0, s7
    s_add_u32 s7, s7, 7040
    buffer_load_dwordx4 v247, s[20:23], s6 offen lds
    s_add_u32 s6, s6, 7040
    s_mov_b64 exec, s[36:37]
    ds_read_b32 v58, v58 offset:9216
    s_mov_b64 exec, s[38:39]
    ds_read_b32 v59, v59 offset:9216
    s_mov_b64 exec, -1
    v_mov_b32 v137, 0
    v_mov_b32 v138, 0
    v_mov_b32 v139, 0
    v_mov_b32 v140, 0
    v_mov_b32 v141, 0
    v_mov_b32 v142, 0
    v_mov_b32 v143, 0
    v_mov_b32 v144, 0
    v_mov_b32 v145, 0
    v_mov_b32 v146, 0
    s_mov_b32 exec_hi, 0x7fffff
    s_mov_b32 m0, s7
    s_add_u32 s7, s7, 7040
    buffer_load_dwordx4 v247, s[20:23], s6 offen lds
    s_add_u32 s6, s6, 7040
    s_mov_b64 exec, s[40:41]
    ds_read_b32 v60, v60 offset:9216
    s_mov_b64 exec, -1
    s_waitcnt lgkmcnt(4)
    v_add_u32 v56, v56, v92
    ds_write_b32 v56, v52 offset:57408
    v_lshrrev_b32 v92, 1, v56
    ds_write_b16 v92, v54 offset:55360
    s_mov_b64 exec, s[42:43]
    ds_read_b32 v61, v61 offset:9216
    s_mov_b64 exec, -1
    v_mov_b32 v147, 0
    v_mov_b32 v148, 0
    v_mov_b32 v149, 0
    v_mov_b32 v150, 0
    v_mov_b32 v151, 0
    v_mov_b32 v152, 0
    v_mov_b32 v153, 0
    v_mov_b32 v154, 0
    v_mov_b32 v155, 0
    v_mov_b32 v156, 0
    s_mov_b32 exec_hi, 0x7fffff
    s_mov_b32 m0, s7
    s_add_u32 s7, s7, 7040
    buffer_load_dwordx4 v247, s[20:23], s6 offen lds
    s_add_u32 s6, s6, 7040
    s_mov_b32 exec_lo, s34
    s_mov_b32 exec_hi, 0
    s_waitcnt lgkmcnt(6)
    v_add_u32 v57, v57, v93
    ds_write_b32 v57, v53 offset:57408
    v_lshrrev_b32 v93, 1, v57
    ds_write_b16 v93, v54 offset:55360
    s_mov_b64 exec, s[44:45]
    ds_read_b32 v62, v62 offset:9216
    s_mov_b64 exec, s[36:37]
    s_waitcnt lgkmcnt(8)
    v_add_u32 v58, v58, v94
    ds_write_b32 v58, v0 offset:57408
    v_lshrrev_b32 v94, 1, v58
    ds_write_b16 v94, v32 offset:55360
    s_mov_b64 exec, s[46:47]
    ds_read_b32 v63, v63 offset:9216
    s_mov_b64 exec, -1
    v_mov_b32 v52, 0
    v_mov_b32 v53, 0
    v_mov_b32 v54, 0
    v_mov_b32 v56, 0
    v_mov_b32 v57, 0
    v_mov_b32 v92, 0
    v_mov_b32 v93, 0
    v_mov_b32 v157, 0
    v_mov_b32 v158, 0
    v_mov_b32 v159, 0
    s_mov_b32 exec_hi, 0x7fffff
    s_mov_b32 m0, s7
    s_add_u32 s7, s7, 7040
    buffer_load_dwordx4 v247, s[20:23], s6 offen lds
    s_add_u32 s6, s6, 7040
    s_mov_b64 exec, s[38:39]
    s_waitcnt lgkmcnt(10)
    v_add_u32 v59, v59, v95
    ds_write_b32 v59, v1 offset:57408
    v_lshrrev_b32 v95, 1, v59
    ds_write_b16_d16_hi v95, v32 offset:55360
    s_mov_b64 exec, s[48:49]
    ds_read_b32 v64, v64 offset:9216
    s_mov_b64 exec, s[40:41]
    s_waitcnt lgkmcnt(12)
    v_add_u32 v60, v60, v96
    ds_write_b32 v60, v2 offset:57408
    v_lshrrev_b32 v96, 1, v60
    ds_write_b16 v96, v33 offset:55360
    s_mov_b64 exec, s[50:51]
    ds_read_b32 v65, v65 offset:9216
    s_mov_b64 exec, -1
    v_mov_b32 v0, 0
    v_mov_b32 v1, 0
    v_mov_b32 v32, 0
    v_mov_b32 v58, 0
    v_mov_b32 v59, 0
    v_mov_b32 v94, 0
    v_mov_b32 v95, 0
    s_mov_b32 exec_hi, 0x7fffff
    s_mov_b32 m0, s7
    s_add_u32 s7, s7, 7040
    buffer_load_dwordx4 v247, s[20:23], s6 offen lds
    s_add_u32 s6, s6, 7040
    s_mov_b64 exec, s[42:43]
    s_waitcnt lgkmcnt(12)
    v_add_u32 v61, v61, v97
    ds_write_b32 v61, v3 offset:57408
    v_lshrrev_b32 v97, 1, v61
    ds_write_b16_d16_hi v97, v33 offset:55360
    s_mov_b64 exec, s[52:53]
    ds_read_b32 v66, v66 offset:9216
    s_mov_b64 exec, s[44:45]
    s_waitcnt lgkmcnt(12)
    v_add_u32 v62, v62, v98
    ds_write_b32 v62, v4 offset:57408
    v_lshrrev_b32 v98, 1, v62
    ds_write_b16 v98, v34 offset:55360
    s_mov_b64 exec, s[54:55]
    ds_read_b32 v67, v67 offset:9216
    s_mov_b64 exec, -1
    v_mov_b32 v2, 0
    v_mov_b32 v3, 0
    v_mov_b32 v33, 0
    v_mov_b32 v60, 0
    v_mov_b32 v61, 0
    v_mov_b32 v96, 0
    v_mov_b32 v97, 0
    s_mov_b32 exec_hi, 0x7fffff
    s_mov_b32 m0, s7
    s_add_u32 s7, s7, 7040
    buffer_load_dwordx4 v247, s[20:23], s6 offen lds
    s_add_u32 s6, s6, 7040
    s_mov_b64 exec, s[46:47]
    s_waitcnt lgkmcnt(12)
    v_add_u32 v63, v63, v99
    ds_write_b32 v63, v5 offset:57408
    v_lshrrev_b32 v99, 1, v63
    ds_write_b16_d16_hi v99, v34 offset:55360
    s_mov_b64 exec, s[56:57]
    ds_read_b32 v68, v68 offset:9216
    s_mov_b64 exec, s[48:49]
    s_waitcnt lgkmcnt(12)
    v_add_u32 v64, v64, v100
    ds_write_b32 v64, v6 offset:57408
    v_lshrrev_b32 v100, 1, v64
    ds_write_b16 v100, v35 offset:55360
    s_mov_b64 exec, s[58:59]
    ds_read_b32 v69, v69 offset:9216
    s_mov_b64 exec, -1
    v_mov_b32 v4, 0
    v_mov_b32 v5, 0
    v_mov_b32 v34, 0
    v_mov_b32 v62, 0
    v_mov_b32 v63, 0
    v_mov_b32 v98, 0
    v_mov_b32 v99, 0
    s_mov_b32 exec_hi, 0x7fffff
    s_mov_b32 m0, s7
    s_add_u32 s7, s7, 7040
    buffer_load_dwordx4 v247, s[20:23], s6 offen lds
    s_add_u32 s6, s6, 7040
    s_mov_b64 exec, s[50:51]
    s_waitcnt lgkmcnt(12)
    v_add_u32 v65, v65, v101
    ds_write_b32 v65, v7 offset:57408
    v_lshrrev_b32 v101, 1, v65
    ds_write_b16_d16_hi v101, v35 offset:55360
    s_mov_b64 exec, s[60:61]
    ds_read_b32 v70, v70 offset:9216
    s_mov_b64 exec, s[52:53]
    s_waitcnt lgkmcnt(12)
    v_add_u32 v66, v66, v102
    ds_write_b32 v66, v8 offset:57408
    v_lshrrev_b32 v102, 1, v66
    ds_write_b16 v102, v36 offset:55360
    s_mov_b64 exec, s[62:63]
    ds_read_b32 v71, v71 offset:9216
    s_mov_b64 exec, -1
    v_mov_b32 v6, 0
    v_mov_b32 v7, 0
    v_mov_b32 v35, 0
    v_mov_b32 v64, 0
    v_mov_b32 v65, 0
    v_mov_b32 v100, 0
    v_mov_b32 v101, 0
    buffer_load_dwordx4 v[184:187], v247, s[8:11], s100 offen
    s_add_u32 s100, s100, 262144
    s_mov_b64 exec, s[54:55]
    s_waitcnt lgkmcnt(12)
    v_add_u32 v67, v67, v103
    ds_write_b32 v67, v9 offset:57408
    v_lshrrev_b32 v103, 1, v67
    ds_write_b16_d16_hi v103, v36 offset:55360
    s_mov_b64 exec, s[64:65]
    ds_read_b32 v72, v72 offset:9216
    s_mov_b64 exec, s[56:57]
    s_waitcnt lgkmcnt(12)
    v_add_u32 v68, v68, v104
    ds_write_b32 v68, v10 offset:57408
    v_lshrrev_b32 v104, 1, v68
    ds_write_b16 v104, v37 offset:55360
    s_mov_b64 exec, s[66:67]
    ds_read_b32 v73, v73 offset:9216
    s_mov_b64 exec, -1
    v_mov_b32 v8, 0
    v_mov_b32 v9, 0
    v_mov_b32 v36, 0
    v_mov_b32 v66, 0
    v_mov_b32 v67, 0
    v_mov_b32 v102, 0
    v_mov_b32 v103, 0
    buffer_load_dwordx4 v[184:187], v247, s[8:11], s100 offen
    s_add_u32 s100, s100, 262144
    s_mov_b64 exec, s[58:59]
    s_waitcnt lgkmcnt(12)
    v_add_u32 v69, v69, v105
    ds_write_b32 v69, v11 offset:57408
    v_lshrrev_b32 v105, 1, v69
    ds_write_b16_d16_hi v105, v37 offset:55360
    s_mov_b64 exec, s[68:69]
    ds_read_b32 v74, v74 offset:9216
    s_mov_b64 exec, s[60:61]
    s_waitcnt lgkmcnt(12)
    v_add_u32 v70, v70, v106
    ds_write_b32 v70, v12 offset:57408
    v_lshrrev_b32 v106, 1, v70
    ds_write_b16 v106, v38 offset:55360
    s_mov_b64 exec, s[70:71]
    ds_read_b32 v75, v75 offset:9216
    s_mov_b64 exec, -1
    v_mov_b32 v10, 0
    v_mov_b32 v11, 0
    v_mov_b32 v37, 0
    v_mov_b32 v68, 0
    v_mov_b32 v69, 0
    v_mov_b32 v104, 0
    v_mov_b32 v105, 0
    buffer_load_dwordx4 v[184:187], v247, s[8:11], s100 offen
    s_add_u32 s100, s100, 262144
    s_mov_b64 exec, s[62:63]
    s_waitcnt lgkmcnt(12)
    v_add_u32 v71, v71, v107
    ds_write_b32 v71, v13 offset:57408
    v_lshrrev_b32 v107, 1, v71
    ds_write_b16_d16_hi v107, v38 offset:55360
    s_mov_b64 exec, s[72:73]
    ds_read_b32 v76, v76 offset:9216
    s_mov_b64 exec, s[64:65]
    s_waitcnt lgkmcnt(12)
    v_add_u32 v72, v72, v108
    ds_write_b32 v72, v14 offset:57408
    v_lshrrev_b32 v108, 1, v72
    ds_write_b16 v108, v39 offset:55360
    s_mov_b64 exec, s[74:75]
    ds_read_b32 v77, v77 offset:9216
    s_mov_b64 exec, -1
    v_mov_b32 v12, 0
    v_mov_b32 v13, 0
    v_mov_b32 v38, 0
    v_mov_b32 v70, 0
    v_mov_b32 v71, 0
    v_mov_b32 v106, 0
    v_mov_b32 v107, 0
    buffer_load_dwordx4 v[184:187], v247, s[8:11], s100 offen
    s_add_u32 s100, s100, 262144
    s_mov_b64 exec, s[66:67]
    s_waitcnt lgkmcnt(12)
    v_add_u32 v73, v73, v109
    ds_write_b32 v73, v15 offset:57408
    v_lshrrev_b32 v109, 1, v73
    ds_write_b16_d16_hi v109, v39 offset:55360
    s_mov_b64 exec, s[76:77]
    ds_read_b32 v78, v78 offset:9216
    s_mov_b64 exec, s[68:69]
    s_waitcnt lgkmcnt(12)
    v_add_u32 v74, v74, v110
    ds_write_b32 v74, v16 offset:57408
    v_lshrrev_b32 v110, 1, v74
    ds_write_b16 v110, v40 offset:55360
    s_mov_b64 exec, s[78:79]
    ds_read_b32 v79, v79 offset:9216
    s_mov_b64 exec, -1
    v_mov_b32 v14, 0
    v_mov_b32 v15, 0
    v_mov_b32 v39, 0
    v_mov_b32 v72, 0
    v_mov_b32 v73, 0
    v_mov_b32 v108, 0
    v_mov_b32 v109, 0
    buffer_load_dwordx4 v[184:187], v247, s[8:11], s100 offen
    s_add_u32 s100, s100, 262144
    s_mov_b64 exec, s[70:71]
    s_waitcnt lgkmcnt(12)
    v_add_u32 v75, v75, v111
    ds_write_b32 v75, v17 offset:57408
    v_lshrrev_b32 v111, 1, v75
    ds_write_b16_d16_hi v111, v40 offset:55360
    s_mov_b64 exec, s[80:81]
    ds_read_b32 v80, v80 offset:9216
    s_mov_b64 exec, s[72:73]
    s_waitcnt lgkmcnt(12)
    v_add_u32 v76, v76, v112
    ds_write_b32 v76, v18 offset:57408
    v_lshrrev_b32 v112, 1, v76
    ds_write_b16 v112, v41 offset:55360
    s_mov_b64 exec, s[82:83]
    ds_read_b32 v81, v81 offset:9216
    s_mov_b64 exec, -1
    v_mov_b32 v16, 0
    v_mov_b32 v17, 0
    v_mov_b32 v40, 0
    v_mov_b32 v74, 0
    v_mov_b32 v75, 0
    v_mov_b32 v110, 0
    v_mov_b32 v111, 0
    buffer_load_dwordx4 v[184:187], v247, s[8:11], s100 offen
    s_add_u32 s100, s100, 262144
    s_mov_b64 exec, s[74:75]
    s_waitcnt lgkmcnt(12)
    v_add_u32 v77, v77, v113
    ds_write_b32 v77, v19 offset:57408
    v_lshrrev_b32 v113, 1, v77
    ds_write_b16_d16_hi v113, v41 offset:55360
    s_mov_b64 exec, s[84:85]
    ds_read_b32 v82, v82 offset:9216
    s_mov_b64 exec, s[76:77]
    s_waitcnt lgkmcnt(12)
    v_add_u32 v78, v78, v114
    ds_write_b32 v78, v20 offset:57408
    v_lshrrev_b32 v114, 1, v78
    ds_write_b16 v114, v42 offset:55360
    s_mov_b64 exec, s[86:87]
    ds_read_b32 v83, v83 offset:9216
    s_mov_b64 exec, -1
    v_mov_b32 v18, 0
    v_mov_b32 v19, 0
    v_mov_b32 v41, 0
    v_mov_b32 v76, 0
    v_mov_b32 v77, 0
    v_mov_b32 v112, 0
    v_mov_b32 v113, 0
    v_lshrrev_b32 v164, 5, v254
    v_lshrrev_b32 v171, 4, v254
    v_and_b32 v168, 1, v254
    v_cmp_eq_u32 s[4:5], v168, v164
    v_bfe_u32 v169, v254, 2, 1
    v_cmp_eq_u32 vcc, 0, v169
    s_and_b64 s[24:25], s[4:5], vcc
    s_andn2_b64 s[26:27], s[4:5], vcc
    v_bfe_u32 v170, v254, 1, 1
    v_lshlrev_b32 v168, 4, v168
    v_mov_b32 v172, 0x3f80
    v_lshlrev_b32 v168, v168, v172
    v_sub_u32 v172, v171, v170
    v_bfe_u32 v173, v254, 2, 2
    v_lshl_add_u32 v173, v172, 2, v173
    s_mov_b64 exec, s[78:79]
    s_waitcnt lgkmcnt(12)
    v_add_u32 v79, v79, v115
    ds_write_b32 v79, v21 offset:57408
    v_lshrrev_b32 v115, 1, v79
    ds_write_b16_d16_hi v115, v42 offset:55360
    s_mov_b64 exec, s[88:89]
    ds_read_b32 v84, v84 offset:9216
    s_mov_b64 exec, s[80:81]
    s_waitcnt lgkmcnt(12)
    v_add_u32 v80, v80, v116
    ds_write_b32 v80, v22 offset:57408
    v_lshrrev_b32 v116, 1, v80
    ds_write_b16 v116, v43 offset:55360
    s_mov_b64 exec, s[90:91]
    ds_read_b32 v85, v85 offset:9216
    s_mov_b64 exec, -1
    v_mov_b32 v20, 0
    v_mov_b32 v21, 0
    v_mov_b32 v42, 0
    v_mov_b32 v78, 0
    v_mov_b32 v79, 0
    v_mov_b32 v114, 0
    v_mov_b32 v115, 0
    v_cmp_eq_u32 vcc, 0, v173
    s_nop 1
    v_cndmask_b32 v232, 0, v168, vcc
    v_cmp_eq_u32 vcc, 1, v173
    s_nop 1
    v_cndmask_b32 v233, 0, v168, vcc
    v_cmp_eq_u32 vcc, 2, v173
    s_nop 1
    v_cndmask_b32 v234, 0, v168, vcc
    v_cmp_eq_u32 vcc, 3, v173
    s_nop 1
    v_cndmask_b32 v235, 0, v168, vcc
    s_mov_b64 exec, s[82:83]
    s_waitcnt lgkmcnt(12)
    v_add_u32 v81, v81, v117
    ds_write_b32 v81, v23 offset:57408
    v_lshrrev_b32 v117, 1, v81
    ds_write_b16_d16_hi v117, v43 offset:55360
    s_mov_b64 exec, s[92:93]
    ds_read_b32 v86, v86 offset:9216
    s_mov_b64 exec, s[84:85]
    s_waitcnt lgkmcnt(12)
    v_add_u32 v82, v82, v118
    ds_write_b32 v82, v24 offset:57408
    v_lshrrev_b32 v118, 1, v82
    ds_write_b16 v118, v44 offset:55360
    s_mov_b64 exec, s[94:95]
    ds_read_b32 v87, v87 offset:9216
    s_mov_b64 exec, -1
    v_mov_b32 v22, 0
    v_mov_b32 v23, 0
    v_mov_b32 v43, 0
    v_mov_b32 v80, 0
    v_mov_b32 v81, 0
    v_mov_b32 v116, 0
    v_mov_b32 v117, 0
    v_cmp_eq_u32 vcc, 8, v173
    s_nop 1
    v_cndmask_b32 v236, 0, v168, vcc
    v_cmp_eq_u32 vcc, 9, v173
    s_nop 1
    v_cndmask_b32 v237, 0, v168, vcc
    v_cmp_eq_u32 vcc, 10, v173
    s_nop 1
    v_cndmask_b32 v238, 0, v168, vcc
    v_cmp_eq_u32 vcc, 11, v173
    s_nop 1
    v_cndmask_b32 v239, 0, v168, vcc
    s_mov_b64 exec, s[86:87]
    s_waitcnt lgkmcnt(12)
    v_add_u32 v83, v83, v119
    ds_write_b32 v83, v25 offset:57408
    v_lshrrev_b32 v119, 1, v83
    ds_write_b16_d16_hi v119, v44 offset:55360
    s_mov_b64 exec, s[96:97]
    ds_read_b32 v88, v88 offset:9216
    s_mov_b64 exec, s[88:89]
    s_waitcnt lgkmcnt(12)
    v_add_u32 v84, v84, v120
    ds_write_b32 v84, v26 offset:57408
    v_lshrrev_b32 v120, 1, v84
    ds_write_b16 v120, v45 offset:55360
    s_mov_b64 exec, s[98:99]
    ds_read_b32 v89, v89 offset:9216
    s_mov_b64 exec, -1
    v_mov_b32 v24, 0
    v_mov_b32 v25, 0
    v_mov_b32 v44, 0
    v_mov_b32 v82, 0
    v_mov_b32 v83, 0
    v_mov_b32 v118, 0
    v_mov_b32 v119, 0
    s_mov_b64 exec, s[90:91]
    s_waitcnt lgkmcnt(12)
    v_add_u32 v85, v85, v121
    ds_write_b32 v85, v27 offset:57408
    v_lshrrev_b32 v121, 1, v85
    ds_write_b16_d16_hi v121, v45 offset:55360
    s_mov_b64 exec, s[12:13]
    ds_read_b32 v90, v90 offset:9216
    s_mov_b64 exec, s[92:93]
    s_waitcnt lgkmcnt(12)
    v_add_u32 v86, v86, v122
    ds_write_b32 v86, v28 offset:57408
    v_lshrrev_b32 v122, 1, v86
    ds_write_b16 v122, v46 offset:55360
    s_mov_b64 exec, s[14:15]
    ds_read_b32 v91, v91 offset:9216
    s_mov_b64 exec, -1
    v_mov_b32 v26, 0
    v_mov_b32 v27, 0
    v_mov_b32 v45, 0
    v_mov_b32 v84, 0
    v_mov_b32 v85, 0
    v_mov_b32 v120, 0
    v_mov_b32 v121, 0
    s_mov_b64 exec, s[94:95]
    s_waitcnt lgkmcnt(12)
    v_add_u32 v87, v87, v123
    ds_write_b32 v87, v29 offset:57408
    v_lshrrev_b32 v123, 1, v87
    ds_write_b16_d16_hi v123, v46 offset:55360
    s_mov_b64 exec, s[96:97]
    s_waitcnt lgkmcnt(11)
    v_add_u32 v88, v88, v124
    ds_write_b32 v88, v30 offset:57408
    v_lshrrev_b32 v124, 1, v88
    ds_write_b16 v124, v47 offset:55360
    s_mov_b64 exec, -1
    v_mov_b32 v28, 0
    v_mov_b32 v29, 0
    v_mov_b32 v46, 0
    v_mov_b32 v86, 0
    v_mov_b32 v87, 0
    v_mov_b32 v122, 0
    v_mov_b32 v123, 0
    s_mov_b64 exec, s[98:99]
    s_waitcnt lgkmcnt(10)
    v_add_u32 v89, v89, v125
    ds_write_b32 v89, v31 offset:57408
    v_lshrrev_b32 v125, 1, v89
    ds_write_b16_d16_hi v125, v47 offset:55360
    s_mov_b64 exec, s[12:13]
    s_waitcnt lgkmcnt(9)
    v_add_u32 v90, v90, v126
    ds_write_b32 v90, v48 offset:57408
    v_lshrrev_b32 v126, 1, v90
    ds_write_b16 v126, v49 offset:55360
    s_mov_b64 exec, -1
    v_mov_b32 v30, 0
    v_mov_b32 v31, 0
    v_mov_b32 v47, 0
    v_mov_b32 v88, 0
    v_mov_b32 v89, 0
    v_mov_b32 v124, 0
    v_mov_b32 v125, 0
    s_mov_b64 exec, s[14:15]
    s_waitcnt lgkmcnt(8)
    v_add_u32 v91, v91, v127
    ds_write_b32 v91, v50 offset:57408
    v_lshrrev_b32 v127, 1, v91
    ds_write_b16 v127, v51 offset:55360
    s_mov_b64 exec, -1
    v_mov_b32 v48, 0
    v_mov_b32 v49, 0
    v_mov_b32 v50, 0
    v_mov_b32 v51, 0
    v_mov_b32 v90, 0
    v_mov_b32 v91, 0
    v_mov_b32 v126, 0
    v_mov_b32 v127, 0
LM_tail:
    s_load_dwordx2 s[12:13], s[0:1], 72
    s_add_u32 s28, s28, 31
    s_and_b32 s28, s28, -32
    s_mul_i32 s5, s3, 6656
    s_mul_i32 s44, s101, 2048
    s_cmp_lg_u32 s35, 0
    s_cselect_b32 s44, 0, s44
    s_cselect_b32 s48, 0, 28096
    s_mov_b32 s47, -3456
    s_mov_b32 s45, 56448
    s_mov_b32 s46, 0x0c040c00
    s_mul_i32 s4, s3, 880
    s_add_u32 s51, s4, 79808
    s_add_u32 s50, s4, 65728
    s_lshl_b32 s49, s44, 1
    s_add_u32 s49, s49, s4
    s_add_u32 s49, s49, 49280
    v_lshlrev_b32 v247, 4, v254
    v_and_b32 v160, 15, v254
    v_lshrrev_b32 v161, 4, v254
    v_lshl_add_u32 v160, v160, 2, v161
    s_lshr_b32 s6, s5, 1
    s_add_u32 s5, s5, 106560
    s_add_u32 s6, s6, 79936
    v_lshl_add_u32 v246, v160, 2, s5
    v_lshl_add_u32 v243, v160, 1, s6
    s_lshl_b32 s4, s3, 10
    s_add_u32 s4, s4, 1024
    v_lshl_add_u32 v253, v160, 3, s4
    v_bfe_u32 v160, v254, 3, 2
    v_bfe_u32 v161, v254, 1, 1
    v_lshl_add_u32 v160, v160, 1, v161
    v_lshl_add_u32 v160, v160, 3, s4
    s_mov_b32 s55, s2
    s_lshl_b32 s55, s55, 5
    s_lshl_b32 s4, s3, 2
    s_add_u32 s55, s55, s4
    s_lshl_b32 s55, s55, 8
    s_mov_b32 s14, 40960000
    s_mov_b32 s15, 0x20000
    s_waitcnt vmcnt(6) lgkmcnt(0)
    s_barrier
    ds_read_b32 v241, v246 offset:0
    ds_read_u16 v244, v243 offset:0
    v_cndmask_b32 v248, 0, v160, s[24:25]
    v_cndmask_b32 v249, 0, v160, s[26:27]
    s_waitcnt lgkmcnt(0)
    v_and_b32 v242, 0x3ffff00, v241
    v_bfe_u32 v251, v241, 8, 18
    v_subrev_u32 v251, s44, v251
    v_add_u32 v252, 160000, v251
    v_min_u32 v251, v251, v252
    v_subrev_u32 v251, s47, v251
    v_lshl_add_u32 v252, v251, 1, s45
    v_cmp_le_u32 s[52:53], s48, v251
    v_subrev_u32 v251, 63360, v252
    v_min_u32 v252, v251, v252
    v_cmp_le_i32 vcc, 0xc0000000, v241
    ds_read_u16 v245, v252 offset:16448
    s_and_b64 s[52:53], s[52:53], vcc
    v_or_b32_dpp v251, v242, v250 row_newbcast:0 row_mask:0xf bank_mask:0xf
    buffer_load_dwordx4 v[160:163], v251, s[8:11], 0 offen
    v_or_b32_dpp v252, v242, v250 row_newbcast:1 row_mask:0xf bank_mask:0xf
    buffer_load_dwordx4 v[164:167], v252, s[8:11], 0 offen
    v_or_b32_dpp v251, v242, v250 row_newbcast:2 row_mask:0xf bank_mask:0xf
    buffer_load_dwordx4 v[168:171], v251, s[8:11], 0 offen
    v_or_b32_dpp v252, v242, v250 row_newbcast:3 row_mask:0xf bank_mask:0xf
    buffer_load_dwordx4 v[172:175], v252, s[8:11], 0 offen
    v_or_b32_dpp v251, v242, v250 row_newbcast:4 row_mask:0xf bank_mask:0xf
    buffer_load_dwordx4 v[176:179], v251, s[8:11], 0 offen
    v_or_b32_dpp v252, v242, v250 row_newbcast:5 row_mask:0xf bank_mask:0xf
    buffer_load_dwordx4 v[180:183], v252, s[8:11], 0 offen
    v_or_b32_dpp v251, v242, v250 row_newbcast:6 row_mask:0xf bank_mask:0xf
    buffer_load_dwordx4 v[184:187], v251, s[8:11], 0 offen
    v_or_b32_dpp v252, v242, v250 row_newbcast:7 row_mask:0xf bank_mask:0xf
    buffer_load_dwordx4 v[188:191], v252, s[8:11], 0 offen
    v_mov_b32_dpp v240, v241 row_shl:1 row_mask:0xf bank_mask:0xf
    v_perm_b32 v240, v240, v241, s46
    v_or_b32 v240, 0xc000c000, v240
    s_waitcnt lgkmcnt(0)
    s_cmp_eq_u64 s[52:53], 0
    s_cbranch_scc1 LM_inwin0
    s_waitcnt lgkmcnt(0)
    s_mov_b64 exec, s[52:53]
    v_bfe_u32 v245, v241, 8, 18
    v_lshlrev_b32 v245, 1, v245
    buffer_load_ushort v245, v245, s[20:23], 0 offen
    s_mov_b64 exec, -1
    s_waitcnt vmcnt(0)
LM_inwin0:
    v_lshlrev_b32 v244, 16, v244
    v_mul_f32 v208, s30, v244
    v_mul_f32 v209, s31, v244
    v_mul_f32 v210, s32, v244
    v_cvt_pk_bf16_f32 v209, v208, v209
    v_cvt_pk_bf16_f32 v210, v210, v210
    v_lshlrev_b32 v244, 16, v209
    v_and_b32 v255, 0xffff0000, v209
    v_and_b32 v254, 0xffff0000, v210
    v_mul_f32 v208, 0x3e22f900, v244
    v_mul_f32 v209, 0x3e22f900, v255
    v_mul_f32 v210, 0x3e22f900, v254
    v_fract_f32 v208, v208
    v_fract_f32 v209, v209
    v_fract_f32 v210, v210
    v_fmamk_f32 v244, v244, 0x36036e4e, v208
    v_fmamk_f32 v255, v255, 0x36036e4e, v209
    v_fmamk_f32 v254, v254, 0x36036e4e, v210
    v_cos_f32 v244, v244
    v_cos_f32 v255, v255
    v_cos_f32 v254, v254
    s_nop 0
    v_cvt_pk_bf16_f32 v255, v244, v255
    v_cvt_pk_bf16_f32 v254, v254, v254
    v_lshlrev_b32 v245, 16, v245
    v_ashrrev_i32 v211, 31, v241
    v_bfe_i32 v212, v241, 30, 1
    v_bfi_b32 v211, v211, 0, v245
    v_and_b32 v212, v212, v245
    v_lshlrev_b32 v244, 16, v255
    v_and_b32 v255, 0xffff0000, v255
    v_and_b32 v254, 0xffff0000, v254
    v_mul_f32 v208, v244, v211
    v_mul_f32 v209, v255, v211
    v_mul_f32 v210, v254, v211
    v_cvt_pk_bf16_f32 v208, v208, v209
    v_cvt_pk_bf16_f32 v209, v210, v212
    ds_write_b64 v253, v[208:209]
    v_xor_b32 v253, 512, v253
    ds_read_b64 v[224:225], v248 offset:0
    ds_read_b64 v[226:227], v249 offset:0
    s_waitcnt lgkmcnt(0)
    v_mfma_f32_32x32x16_bf16 v[192:207], v[224:227], v[228:231], 0
    ds_read_b32 v241, v246 offset:256
    ds_read_u16 v244, v243 offset:128
    s_cmp_lt_u32 s3, 4
    s_cbranch_scc1 LM_prio
    s_setprio 1
LM_prio:
    s_cmp_le_u32 s28, 32
    s_cbranch_scc1 LM_drainA
.p2align 6
LM_loop:
    s_waitcnt vmcnt(6)
    v_mfma_f32_16x16x32_bf16 v[208:211], v[232:235], v[160:163], 0
    ds_read_b64 v[224:225], v248 offset:64
    ds_read_b64 v[226:227], v249 offset:64
    v_mfma_f32_16x16x32_bf16 v[212:215], v[236:239], v[160:163], 0
    s_mov_b32 m0, s50
    s_add_u32 s50, s50, 7040
    buffer_load_dwordx4 v247, s[20:23], s49 offen lds
    v_or_b32_dpp v251, v242, v250 row_newbcast:8 row_mask:0xf bank_mask:0xf
    buffer_load_dwordx4 v[160:163], v251, s[8:11], 0 offen
    v_mfma_f32_16x16x32_bf16 v[216:219], v[232:235], v[164:167], 0
    v_readlane_b32 s36, v240, 0
    v_readlane_b32 s37, v240, 16
    v_mfma_f32_16x16x32_bf16 v[220:223], v[236:239], v[164:167], 0
    v_or_b32_dpp v252, v242, v250 row_newbcast:9 row_mask:0xf bank_mask:0xf
    v_readlane_b32 s38, v240, 32
    v_readlane_b32 s39, v240, 48
    s_barrier
    s_set_gpr_idx_on s36, gpr_idx(SRC2,DST)
    v_pk_fma_f32 v[0:1], v[208:209], v[192:193], v[0:1]
    s_mov_b32 m0, s37
    v_pk_fma_f32 v[0:1], v[210:211], v[194:195], v[0:1]
    s_mov_b32 m0, s38
    v_pk_fma_f32 v[0:1], v[212:213], v[196:197], v[0:1]
    s_mov_b32 m0, s39
    v_pk_fma_f32 v[0:1], v[214:215], v[198:199], v[0:1]
    s_lshr_b32 m0, s36, 16
    v_pk_fma_f32 v[0:1], v[216:217], v[200:201], v[0:1]
    s_lshr_b32 m0, s37, 16
    v_pk_fma_f32 v[0:1], v[218:219], v[202:203], v[0:1]
    s_lshr_b32 m0, s38, 16
    v_pk_fma_f32 v[0:1], v[220:221], v[204:205], v[0:1]
    s_lshr_b32 m0, s39, 16
    v_pk_fma_f32 v[0:1], v[222:223], v[206:207], v[0:1]
    s_set_gpr_idx_off
    buffer_load_dwordx4 v[164:167], v252, s[8:11], 0 offen
    s_waitcnt lgkmcnt(0)
    v_mfma_f32_32x32x16_bf16 v[192:207], v[224:227], v[228:231], 0
    v_bfe_u32 v251, v241, 8, 18
    v_subrev_u32 v251, s44, v251
    v_add_u32 v252, 160000, v251
    v_min_u32 v251, v251, v252
    v_subrev_u32 v251, s47, v251
    v_lshl_add_u32 v252, v251, 1, s45
    v_cmp_le_u32 s[52:53], s48, v251
    v_subrev_u32 v251, 63360, v252
    v_min_u32 v252, v251, v252
    v_cmp_le_i32 vcc, 0xc0000000, v241
    ds_read_u16 v245, v252 offset:16448
    s_and_b64 s[52:53], s[52:53], vcc
    s_cmp_eq_u64 s[52:53], 0
    s_cbranch_scc1 LM_inwin
    s_waitcnt lgkmcnt(0)
    s_mov_b64 exec, s[52:53]
    v_bfe_u32 v245, v241, 8, 18
    v_lshlrev_b32 v245, 1, v245
    buffer_load_ushort v245, v245, s[20:23], 0 offen
    s_mov_b64 exec, -1
LM_inwin:
    s_waitcnt vmcnt(7)
    v_mfma_f32_16x16x32_bf16 v[208:211], v[232:235], v[168:171], 0
    ds_read_b64 v[224:225], v248 offset:128
    ds_read_b64 v[226:227], v249 offset:128
    v_mfma_f32_16x16x32_bf16 v[212:215], v[236:239], v[168:171], 0
    v_or_b32_dpp v251, v242, v250 row_newbcast:10 row_mask:0xf bank_mask:0xf
    buffer_load_dwordx4 v[168:171], v251, s[8:11], 0 offen
    v_mfma_f32_16x16x32_bf16 v[216:219], v[232:235], v[172:175], 0
    v_readlane_b32 s36, v240, 2
    v_readlane_b32 s37, v240, 18
    v_mfma_f32_16x16x32_bf16 v[220:223], v[236:239], v[172:175], 0
    v_or_b32_dpp v252, v242, v250 row_newbcast:11 row_mask:0xf bank_mask:0xf
    v_readlane_b32 s38, v240, 34
    v_readlane_b32 s39, v240, 50
    s_barrier
    s_set_gpr_idx_on s36, gpr_idx(SRC2,DST)
    v_pk_fma_f32 v[0:1], v[208:209], v[192:193], v[0:1]
    s_mov_b32 m0, s37
    v_pk_fma_f32 v[0:1], v[210:211], v[194:195], v[0:1]
    s_mov_b32 m0, s38
    v_pk_fma_f32 v[0:1], v[212:213], v[196:197], v[0:1]
    s_mov_b32 m0, s39
    v_pk_fma_f32 v[0:1], v[214:215], v[198:199], v[0:1]
    s_lshr_b32 m0, s36, 16
    v_pk_fma_f32 v[0:1], v[216:217], v[200:201], v[0:1]
    s_lshr_b32 m0, s37, 16
    v_pk_fma_f32 v[0:1], v[218:219], v[202:203], v[0:1]
    s_lshr_b32 m0, s38, 16
    v_pk_fma_f32 v[0:1], v[220:221], v[204:205], v[0:1]
    s_lshr_b32 m0, s39, 16
    v_pk_fma_f32 v[0:1], v[222:223], v[206:207], v[0:1]
    s_set_gpr_idx_off
    buffer_load_dwordx4 v[172:175], v252, s[8:11], 0 offen
    s_waitcnt lgkmcnt(0)
    v_mfma_f32_32x32x16_bf16 v[192:207], v[224:227], v[228:231], 0
    s_cmp_ge_u32 s50, s51
    s_cselect_b32 s4, 63360, 0
    s_sub_u32 s50, s50, s4
    s_add_u32 s49, s49, 7040
    v_lshlrev_b32 v244, 16, v244
    v_mul_f32 v208, s30, v244
    v_mul_f32 v209, s31, v244
    v_mul_f32 v210, s32, v244
    v_cvt_pk_bf16_f32 v209, v208, v209
    v_cvt_pk_bf16_f32 v210, v210, v210
    v_lshlrev_b32 v244, 16, v209
    v_and_b32 v255, 0xffff0000, v209
    v_and_b32 v254, 0xffff0000, v210
    s_waitcnt vmcnt(7)
    v_mfma_f32_16x16x32_bf16 v[208:211], v[232:235], v[176:179], 0
    ds_read_b64 v[224:225], v248 offset:192
    ds_read_b64 v[226:227], v249 offset:192
    v_mfma_f32_16x16x32_bf16 v[212:215], v[236:239], v[176:179], 0
    v_or_b32_dpp v251, v242, v250 row_newbcast:12 row_mask:0xf bank_mask:0xf
    buffer_load_dwordx4 v[176:179], v251, s[8:11], 0 offen
    v_mfma_f32_16x16x32_bf16 v[216:219], v[232:235], v[180:183], 0
    v_readlane_b32 s36, v240, 4
    v_readlane_b32 s37, v240, 20
    v_mfma_f32_16x16x32_bf16 v[220:223], v[236:239], v[180:183], 0
    v_or_b32_dpp v252, v242, v250 row_newbcast:13 row_mask:0xf bank_mask:0xf
    v_readlane_b32 s38, v240, 36
    v_readlane_b32 s39, v240, 52
    s_barrier
    s_set_gpr_idx_on s36, gpr_idx(SRC2,DST)
    v_pk_fma_f32 v[0:1], v[208:209], v[192:193], v[0:1]
    s_mov_b32 m0, s37
    v_pk_fma_f32 v[0:1], v[210:211], v[194:195], v[0:1]
    s_mov_b32 m0, s38
    v_pk_fma_f32 v[0:1], v[212:213], v[196:197], v[0:1]
    s_mov_b32 m0, s39
    v_pk_fma_f32 v[0:1], v[214:215], v[198:199], v[0:1]
    s_lshr_b32 m0, s36, 16
    v_pk_fma_f32 v[0:1], v[216:217], v[200:201], v[0:1]
    s_lshr_b32 m0, s37, 16
    v_pk_fma_f32 v[0:1], v[218:219], v[202:203], v[0:1]
    s_lshr_b32 m0, s38, 16
    v_pk_fma_f32 v[0:1], v[220:221], v[204:205], v[0:1]
    s_lshr_b32 m0, s39, 16
    v_pk_fma_f32 v[0:1], v[222:223], v[206:207], v[0:1]
    s_set_gpr_idx_off
    buffer_load_dwordx4 v[180:183], v252, s[8:11], 0 offen
    s_waitcnt lgkmcnt(0)
    v_mfma_f32_32x32x16_bf16 v[192:207], v[224:227], v[228:231], 0
    v_mul_f32 v208, 0x3e22f900, v244
    v_mul_f32 v209, 0x3e22f900, v255
    v_mul_f32 v210, 0x3e22f900, v254
    v_fract_f32 v208, v208
    v_fract_f32 v209, v209
    v_fract_f32 v210, v210
    v_fmamk_f32 v244, v244, 0x36036e4e, v208
    v_fmamk_f32 v255, v255, 0x36036e4e, v209
    v_fmamk_f32 v254, v254, 0x36036e4e, v210
    s_waitcnt vmcnt(6)
    v_mfma_f32_16x16x32_bf16 v[208:211], v[232:235], v[184:187], 0
    ds_read_b64 v[224:225], v248 offset:256
    ds_read_b64 v[226:227], v249 offset:256
    v_mfma_f32_16x16x32_bf16 v[212:215], v[236:239], v[184:187], 0
    v_or_b32_dpp v251, v242, v250 row_newbcast:14 row_mask:0xf bank_mask:0xf
    buffer_load_dwordx4 v[184:187], v251, s[8:11], 0 offen
    v_mfma_f32_16x16x32_bf16 v[216:219], v[232:235], v[188:191], 0
    v_readlane_b32 s36, v240, 6
    v_readlane_b32 s37, v240, 22
    v_mfma_f32_16x16x32_bf16 v[220:223], v[236:239], v[188:191], 0
    v_or_b32_dpp v252, v242, v250 row_newbcast:15 row_mask:0xf bank_mask:0xf
    v_readlane_b32 s38, v240, 38
    v_readlane_b32 s39, v240, 54
    s_barrier
    s_set_gpr_idx_on s36, gpr_idx(SRC2,DST)
    v_pk_fma_f32 v[0:1], v[208:209], v[192:193], v[0:1]
    s_mov_b32 m0, s37
    v_pk_fma_f32 v[0:1], v[210:211], v[194:195], v[0:1]
    s_mov_b32 m0, s38
    v_pk_fma_f32 v[0:1], v[212:213], v[196:197], v[0:1]
    s_mov_b32 m0, s39
    v_pk_fma_f32 v[0:1], v[214:215], v[198:199], v[0:1]
    s_lshr_b32 m0, s36, 16
    v_pk_fma_f32 v[0:1], v[216:217], v[200:201], v[0:1]
    s_lshr_b32 m0, s37, 16
    v_pk_fma_f32 v[0:1], v[218:219], v[202:203], v[0:1]
    s_lshr_b32 m0, s38, 16
    v_pk_fma_f32 v[0:1], v[220:221], v[204:205], v[0:1]
    s_lshr_b32 m0, s39, 16
    v_pk_fma_f32 v[0:1], v[222:223], v[206:207], v[0:1]
    s_set_gpr_idx_off
    buffer_load_dwordx4 v[188:191], v252, s[8:11], 0 offen
    s_waitcnt lgkmcnt(0)
    v_mfma_f32_32x32x16_bf16 v[192:207], v[224:227], v[228:231], 0
    v_and_b32 v242, 0x3ffff00, v241
    v_cos_f32 v244, v244
    v_cos_f32 v255, v255
    v_cos_f32 v254, v254
    s_nop 0
    v_cvt_pk_bf16_f32 v255, v244, v255
    v_cvt_pk_bf16_f32 v254, v254, v254
    s_sub_u32 s28, s28, 32
    s_cmp_le_u32 s28, 32
    s_cbranch_scc1 LM_drainB
    s_waitcnt vmcnt(6)
    v_mfma_f32_16x16x32_bf16 v[208:211], v[232:235], v[160:163], 0
    ds_read_b64 v[224:225], v248 offset:320
    ds_read_b64 v[226:227], v249 offset:320
    v_mfma_f32_16x16x32_bf16 v[212:215], v[236:239], v[160:163], 0
    s_mov_b32 m0, s50
    s_add_u32 s50, s50, 7040
    buffer_load_dwordx4 v247, s[20:23], s49 offen lds
    v_or_b32_dpp v251, v242, v250 row_newbcast:0 row_mask:0xf bank_mask:0xf
    buffer_load_dwordx4 v[160:163], v251, s[8:11], 0 offen
    v_mfma_f32_16x16x32_bf16 v[216:219], v[232:235], v[164:167], 0
    v_readlane_b32 s36, v240, 8
    v_readlane_b32 s37, v240, 24
    v_mfma_f32_16x16x32_bf16 v[220:223], v[236:239], v[164:167], 0
    v_or_b32_dpp v252, v242, v250 row_newbcast:1 row_mask:0xf bank_mask:0xf
    v_readlane_b32 s38, v240, 40
    v_readlane_b32 s39, v240, 56
    s_barrier
    s_set_gpr_idx_on s36, gpr_idx(SRC2,DST)
    v_pk_fma_f32 v[0:1], v[208:209], v[192:193], v[0:1]
    s_mov_b32 m0, s37
    v_pk_fma_f32 v[0:1], v[210:211], v[194:195], v[0:1]
    s_mov_b32 m0, s38
    v_pk_fma_f32 v[0:1], v[212:213], v[196:197], v[0:1]
    s_mov_b32 m0, s39
    v_pk_fma_f32 v[0:1], v[214:215], v[198:199], v[0:1]
    s_lshr_b32 m0, s36, 16
    v_pk_fma_f32 v[0:1], v[216:217], v[200:201], v[0:1]
    s_lshr_b32 m0, s37, 16
    v_pk_fma_f32 v[0:1], v[218:219], v[202:203], v[0:1]
    s_lshr_b32 m0, s38, 16
    v_pk_fma_f32 v[0:1], v[220:221], v[204:205], v[0:1]
    s_lshr_b32 m0, s39, 16
    v_pk_fma_f32 v[0:1], v[222:223], v[206:207], v[0:1]
    s_set_gpr_idx_off
    buffer_load_dwordx4 v[164:167], v252, s[8:11], 0 offen
    s_waitcnt lgkmcnt(0)
    v_mfma_f32_32x32x16_bf16 v[192:207], v[224:227], v[228:231], 0
    s_waitcnt vmcnt(9)
    v_lshlrev_b32 v245, 16, v245
    v_ashrrev_i32 v211, 31, v241
    v_bfe_i32 v212, v241, 30, 1
    v_lshlrev_b32 v244, 16, v255
    v_bfi_b32 v211, v211, 0, v245
    v_and_b32 v255, 0xffff0000, v255
    v_and_b32 v254, 0xffff0000, v254
    v_and_b32 v245, v212, v245
    v_mul_f32 v244, v244, v211
    v_mul_f32 v255, v255, v211
    v_mul_f32 v254, v254, v211
    s_waitcnt vmcnt(7)
    v_mfma_f32_16x16x32_bf16 v[208:211], v[232:235], v[168:171], 0
    ds_read_b64 v[224:225], v248 offset:384
    ds_read_b64 v[226:227], v249 offset:384
    v_mfma_f32_16x16x32_bf16 v[212:215], v[236:239], v[168:171], 0
    v_or_b32_dpp v251, v242, v250 row_newbcast:2 row_mask:0xf bank_mask:0xf
    buffer_load_dwordx4 v[168:171], v251, s[8:11], 0 offen
    v_mfma_f32_16x16x32_bf16 v[216:219], v[232:235], v[172:175], 0
    v_readlane_b32 s36, v240, 10
    v_readlane_b32 s37, v240, 26
    v_mfma_f32_16x16x32_bf16 v[220:223], v[236:239], v[172:175], 0
    v_or_b32_dpp v252, v242, v250 row_newbcast:3 row_mask:0xf bank_mask:0xf
    v_readlane_b32 s38, v240, 42
    v_readlane_b32 s39, v240, 58
    s_barrier
    s_set_gpr_idx_on s36, gpr_idx(SRC2,DST)
    v_pk_fma_f32 v[0:1], v[208:209], v[192:193], v[0:1]
    s_mov_b32 m0, s37
    v_pk_fma_f32 v[0:1], v[210:211], v[194:195], v[0:1]
    s_mov_b32 m0, s38
    v_pk_fma_f32 v[0:1], v[212:213], v[196:197], v[0:1]
    s_mov_b32 m0, s39
    v_pk_fma_f32 v[0:1], v[214:215], v[198:199], v[0:1]
    s_lshr_b32 m0, s36, 16
    v_pk_fma_f32 v[0:1], v[216:217], v[200:201], v[0:1]
    s_lshr_b32 m0, s37, 16
    v_pk_fma_f32 v[0:1], v[218:219], v[202:203], v[0:1]
    s_lshr_b32 m0, s38, 16
    v_pk_fma_f32 v[0:1], v[220:221], v[204:205], v[0:1]
    s_lshr_b32 m0, s39, 16
    v_pk_fma_f32 v[0:1], v[222:223], v[206:207], v[0:1]
    s_set_gpr_idx_off
    buffer_load_dwordx4 v[172:175], v252, s[8:11], 0 offen
    s_waitcnt lgkmcnt(0)
    v_mfma_f32_32x32x16_bf16 v[192:207], v[224:227], v[228:231], 0
    s_cmp_ge_u32 s50, s51
    s_cselect_b32 s4, 63360, 0
    s_sub_u32 s50, s50, s4
    s_add_u32 s49, s49, 7040
    v_cvt_pk_bf16_f32 v208, v244, v255
    v_cvt_pk_bf16_f32 v209, v254, v245
    ds_write_b64 v253, v[208:209]
    v_xor_b32 v253, 512, v253
    s_add_u32 s47, s47, 7040
    s_add_u32 s45, s45, 14080
    s_cmp_ge_u32 s45, 63360
    s_cselect_b32 s4, 63360, 0
    s_sub_u32 s45, s45, s4
    s_waitcnt vmcnt(7)
    v_mfma_f32_16x16x32_bf16 v[208:211], v[232:235], v[176:179], 0
    ds_read_b64 v[224:225], v248 offset:448
    ds_read_b64 v[226:227], v249 offset:448
    v_mfma_f32_16x16x32_bf16 v[212:215], v[236:239], v[176:179], 0
    v_or_b32_dpp v251, v242, v250 row_newbcast:4 row_mask:0xf bank_mask:0xf
    buffer_load_dwordx4 v[176:179], v251, s[8:11], 0 offen
    v_mfma_f32_16x16x32_bf16 v[216:219], v[232:235], v[180:183], 0
    v_readlane_b32 s36, v240, 12
    v_readlane_b32 s37, v240, 28
    v_mfma_f32_16x16x32_bf16 v[220:223], v[236:239], v[180:183], 0
    v_or_b32_dpp v252, v242, v250 row_newbcast:5 row_mask:0xf bank_mask:0xf
    v_readlane_b32 s38, v240, 44
    v_readlane_b32 s39, v240, 60
    s_barrier
    s_set_gpr_idx_on s36, gpr_idx(SRC2,DST)
    v_pk_fma_f32 v[0:1], v[208:209], v[192:193], v[0:1]
    s_mov_b32 m0, s37
    v_pk_fma_f32 v[0:1], v[210:211], v[194:195], v[0:1]
    s_mov_b32 m0, s38
    v_pk_fma_f32 v[0:1], v[212:213], v[196:197], v[0:1]
    s_mov_b32 m0, s39
    v_pk_fma_f32 v[0:1], v[214:215], v[198:199], v[0:1]
    s_lshr_b32 m0, s36, 16
    v_pk_fma_f32 v[0:1], v[216:217], v[200:201], v[0:1]
    s_lshr_b32 m0, s37, 16
    v_pk_fma_f32 v[0:1], v[218:219], v[202:203], v[0:1]
    s_lshr_b32 m0, s38, 16
    v_pk_fma_f32 v[0:1], v[220:221], v[204:205], v[0:1]
    s_lshr_b32 m0, s39, 16
    v_pk_fma_f32 v[0:1], v[222:223], v[206:207], v[0:1]
    s_set_gpr_idx_off
    buffer_load_dwordx4 v[180:183], v252, s[8:11], 0 offen
    s_waitcnt lgkmcnt(0)
    v_mfma_f32_32x32x16_bf16 v[192:207], v[224:227], v[228:231], 0
    v_xor_b32 v248, 512, v248
    v_xor_b32 v249, 512, v249
    s_waitcnt vmcnt(6)
    v_mfma_f32_16x16x32_bf16 v[208:211], v[232:235], v[184:187], 0
    ds_read_b64 v[224:225], v248 offset:0
    ds_read_b64 v[226:227], v249 offset:0
    v_mfma_f32_16x16x32_bf16 v[212:215], v[236:239], v[184:187], 0
    v_or_b32_dpp v251, v242, v250 row_newbcast:6 row_mask:0xf bank_mask:0xf
    buffer_load_dwordx4 v[184:187], v251, s[8:11], 0 offen
    v_mfma_f32_16x16x32_bf16 v[216:219], v[232:235], v[188:191], 0
    v_readlane_b32 s36, v240, 14
    v_readlane_b32 s37, v240, 30
    v_mfma_f32_16x16x32_bf16 v[220:223], v[236:239], v[188:191], 0
    v_or_b32_dpp v252, v242, v250 row_newbcast:7 row_mask:0xf bank_mask:0xf
    v_readlane_b32 s38, v240, 46
    v_readlane_b32 s39, v240, 62
    s_barrier
    s_set_gpr_idx_on s36, gpr_idx(SRC2,DST)
    v_pk_fma_f32 v[0:1], v[208:209], v[192:193], v[0:1]
    s_mov_b32 m0, s37
    v_pk_fma_f32 v[0:1], v[210:211], v[194:195], v[0:1]
    s_mov_b32 m0, s38
    v_pk_fma_f32 v[0:1], v[212:213], v[196:197], v[0:1]
    s_mov_b32 m0, s39
    v_pk_fma_f32 v[0:1], v[214:215], v[198:199], v[0:1]
    s_lshr_b32 m0, s36, 16
    v_pk_fma_f32 v[0:1], v[216:217], v[200:201], v[0:1]
    s_lshr_b32 m0, s37, 16
    v_pk_fma_f32 v[0:1], v[218:219], v[202:203], v[0:1]
    s_lshr_b32 m0, s38, 16
    v_pk_fma_f32 v[0:1], v[220:221], v[204:205], v[0:1]
    s_lshr_b32 m0, s39, 16
    v_pk_fma_f32 v[0:1], v[222:223], v[206:207], v[0:1]
    s_set_gpr_idx_off
    buffer_load_dwordx4 v[188:191], v252, s[8:11], 0 offen
    s_waitcnt lgkmcnt(0)
    v_mfma_f32_32x32x16_bf16 v[192:207], v[224:227], v[228:231], 0
    v_mov_b32_dpp v240, v241 row_shl:1 row_mask:0xf bank_mask:0xf
    v_perm_b32 v240, v240, v241, s46
    v_or_b32 v240, 0xc000c000, v240
    v_add_u32 v246, 256, v246
    v_add_u32 v243, 128, v243
    ds_read_b32 v241, v246 offset:256
    ds_read_u16 v244, v243 offset:128
    s_sub_u32 s28, s28, 32
    s_cmp_gt_u32 s28, 32
    s_cbranch_scc1 LM_loop
LM_drainA:
    s_waitcnt vmcnt(6)
    v_mfma_f32_16x16x32_bf16 v[208:211], v[232:235], v[160:163], 0
    ds_read_b64 v[224:225], v248 offset:64
    ds_read_b64 v[226:227], v249 offset:64
    v_mfma_f32_16x16x32_bf16 v[212:215], v[236:239], v[160:163], 0
    v_mfma_f32_16x16x32_bf16 v[216:219], v[232:235], v[164:167], 0
    v_readlane_b32 s36, v240, 0
    v_readlane_b32 s37, v240, 16
    v_mfma_f32_16x16x32_bf16 v[220:223], v[236:239], v[164:167], 0
    v_readlane_b32 s38, v240, 32
    v_readlane_b32 s39, v240, 48
    s_nop 1
    s_set_gpr_idx_on s36, gpr_idx(SRC2,DST)
    v_pk_fma_f32 v[0:1], v[208:209], v[192:193], v[0:1]
    s_mov_b32 m0, s37
    v_pk_fma_f32 v[0:1], v[210:211], v[194:195], v[0:1]
    s_mov_b32 m0, s38
    v_pk_fma_f32 v[0:1], v[212:213], v[196:197], v[0:1]
    s_mov_b32 m0, s39
    v_pk_fma_f32 v[0:1], v[214:215], v[198:199], v[0:1]
    s_lshr_b32 m0, s36, 16
    v_pk_fma_f32 v[0:1], v[216:217], v[200:201], v[0:1]
    s_lshr_b32 m0, s37, 16
    v_pk_fma_f32 v[0:1], v[218:219], v[202:203], v[0:1]
    s_lshr_b32 m0, s38, 16
    v_pk_fma_f32 v[0:1], v[220:221], v[204:205], v[0:1]
    s_lshr_b32 m0, s39, 16
    v_pk_fma_f32 v[0:1], v[222:223], v[206:207], v[0:1]
    s_set_gpr_idx_off
    s_waitcnt lgkmcnt(0)
    v_mfma_f32_32x32x16_bf16 v[192:207], v[224:227], v[228:231], 0
    s_waitcnt vmcnt(4)
    v_mfma_f32_16x16x32_bf16 v[208:211], v[232:235], v[168:171], 0
    ds_read_b64 v[224:225], v248 offset:128
    ds_read_b64 v[226:227], v249 offset:128
    v_mfma_f32_16x16x32_bf16 v[212:215], v[236:239], v[168:171], 0
    v_mfma_f32_16x16x32_bf16 v[216:219], v[232:235], v[172:175], 0
    v_readlane_b32 s36, v240, 2
    v_readlane_b32 s37, v240, 18
    v_mfma_f32_16x16x32_bf16 v[220:223], v[236:239], v[172:175], 0
    v_readlane_b32 s38, v240, 34
    v_readlane_b32 s39, v240, 50
    s_nop 1
    s_set_gpr_idx_on s36, gpr_idx(SRC2,DST)
    v_pk_fma_f32 v[0:1], v[208:209], v[192:193], v[0:1]
    s_mov_b32 m0, s37
    v_pk_fma_f32 v[0:1], v[210:211], v[194:195], v[0:1]
    s_mov_b32 m0, s38
    v_pk_fma_f32 v[0:1], v[212:213], v[196:197], v[0:1]
    s_mov_b32 m0, s39
    v_pk_fma_f32 v[0:1], v[214:215], v[198:199], v[0:1]
    s_lshr_b32 m0, s36, 16
    v_pk_fma_f32 v[0:1], v[216:217], v[200:201], v[0:1]
    s_lshr_b32 m0, s37, 16
    v_pk_fma_f32 v[0:1], v[218:219], v[202:203], v[0:1]
    s_lshr_b32 m0, s38, 16
    v_pk_fma_f32 v[0:1], v[220:221], v[204:205], v[0:1]
    s_lshr_b32 m0, s39, 16
    v_pk_fma_f32 v[0:1], v[222:223], v[206:207], v[0:1]
    s_set_gpr_idx_off
    s_waitcnt lgkmcnt(0)
    v_mfma_f32_32x32x16_bf16 v[192:207], v[224:227], v[228:231], 0
    s_waitcnt vmcnt(2)
    v_mfma_f32_16x16x32_bf16 v[208:211], v[232:235], v[176:179], 0
    ds_read_b64 v[224:225], v248 offset:192
    ds_read_b64 v[226:227], v249 offset:192
    v_mfma_f32_16x16x32_bf16 v[212:215], v[236:239], v[176:179], 0
    v_mfma_f32_16x16x32_bf16 v[216:219], v[232:235], v[180:183], 0
    v_readlane_b32 s36, v240, 4
    v_readlane_b32 s37, v240, 20
    v_mfma_f32_16x16x32_bf16 v[220:223], v[236:239], v[180:183], 0
    v_readlane_b32 s38, v240, 36
    v_readlane_b32 s39, v240, 52
    s_nop 1
    s_set_gpr_idx_on s36, gpr_idx(SRC2,DST)
    v_pk_fma_f32 v[0:1], v[208:209], v[192:193], v[0:1]
    s_mov_b32 m0, s37
    v_pk_fma_f32 v[0:1], v[210:211], v[194:195], v[0:1]
    s_mov_b32 m0, s38
    v_pk_fma_f32 v[0:1], v[212:213], v[196:197], v[0:1]
    s_mov_b32 m0, s39
    v_pk_fma_f32 v[0:1], v[214:215], v[198:199], v[0:1]
    s_lshr_b32 m0, s36, 16
    v_pk_fma_f32 v[0:1], v[216:217], v[200:201], v[0:1]
    s_lshr_b32 m0, s37, 16
    v_pk_fma_f32 v[0:1], v[218:219], v[202:203], v[0:1]
    s_lshr_b32 m0, s38, 16
    v_pk_fma_f32 v[0:1], v[220:221], v[204:205], v[0:1]
    s_lshr_b32 m0, s39, 16
    v_pk_fma_f32 v[0:1], v[222:223], v[206:207], v[0:1]
    s_set_gpr_idx_off
    s_waitcnt lgkmcnt(0)
    v_mfma_f32_32x32x16_bf16 v[192:207], v[224:227], v[228:231], 0
    s_waitcnt vmcnt(0)
    v_mfma_f32_16x16x32_bf16 v[208:211], v[232:235], v[184:187], 0
    v_mfma_f32_16x16x32_bf16 v[212:215], v[236:239], v[184:187], 0
    v_mfma_f32_16x16x32_bf16 v[216:219], v[232:235], v[188:191], 0
    v_readlane_b32 s36, v240, 6
    v_readlane_b32 s37, v240, 22
    v_mfma_f32_16x16x32_bf16 v[220:223], v[236:239], v[188:191], 0
    v_readlane_b32 s38, v240, 38
    v_readlane_b32 s39, v240, 54
    s_nop 1
    s_set_gpr_idx_on s36, gpr_idx(SRC2,DST)
    v_pk_fma_f32 v[0:1], v[208:209], v[192:193], v[0:1]
    s_mov_b32 m0, s37
    v_pk_fma_f32 v[0:1], v[210:211], v[194:195], v[0:1]
    s_mov_b32 m0, s38
    v_pk_fma_f32 v[0:1], v[212:213], v[196:197], v[0:1]
    s_mov_b32 m0, s39
    v_pk_fma_f32 v[0:1], v[214:215], v[198:199], v[0:1]
    s_lshr_b32 m0, s36, 16
    v_pk_fma_f32 v[0:1], v[216:217], v[200:201], v[0:1]
    s_lshr_b32 m0, s37, 16
    v_pk_fma_f32 v[0:1], v[218:219], v[202:203], v[0:1]
    s_lshr_b32 m0, s38, 16
    v_pk_fma_f32 v[0:1], v[220:221], v[204:205], v[0:1]
    s_lshr_b32 m0, s39, 16
    v_pk_fma_f32 v[0:1], v[222:223], v[206:207], v[0:1]
    s_set_gpr_idx_off
    s_branch LM_drained
LM_drainB:
    s_waitcnt vmcnt(6)
    v_mfma_f32_16x16x32_bf16 v[208:211], v[232:235], v[160:163], 0
    ds_read_b64 v[224:225], v248 offset:320
    ds_read_b64 v[226:227], v249 offset:320
    v_mfma_f32_16x16x32_bf16 v[212:215], v[236:239], v[160:163], 0
    v_mfma_f32_16x16x32_bf16 v[216:219], v[232:235], v[164:167], 0
    v_readlane_b32 s36, v240, 8
    v_readlane_b32 s37, v240, 24
    v_mfma_f32_16x16x32_bf16 v[220:223], v[236:239], v[164:167], 0
    v_readlane_b32 s38, v240, 40
    v_readlane_b32 s39, v240, 56
    s_nop 1
    s_set_gpr_idx_on s36, gpr_idx(SRC2,DST)
    v_pk_fma_f32 v[0:1], v[208:209], v[192:193], v[0:1]
    s_mov_b32 m0, s37
    v_pk_fma_f32 v[0:1], v[210:211], v[194:195], v[0:1]
    s_mov_b32 m0, s38
    v_pk_fma_f32 v[0:1], v[212:213], v[196:197], v[0:1]
    s_mov_b32 m0, s39
    v_pk_fma_f32 v[0:1], v[214:215], v[198:199], v[0:1]
    s_lshr_b32 m0, s36, 16
    v_pk_fma_f32 v[0:1], v[216:217], v[200:201], v[0:1]
    s_lshr_b32 m0, s37, 16
    v_pk_fma_f32 v[0:1], v[218:219], v[202:203], v[0:1]
    s_lshr_b32 m0, s38, 16
    v_pk_fma_f32 v[0:1], v[220:221], v[204:205], v[0:1]
    s_lshr_b32 m0, s39, 16
    v_pk_fma_f32 v[0:1], v[222:223], v[206:207], v[0:1]
    s_set_gpr_idx_off
    s_waitcnt lgkmcnt(0)
    v_mfma_f32_32x32x16_bf16 v[192:207], v[224:227], v[228:231], 0
    s_waitcnt vmcnt(4)
    v_mfma_f32_16x16x32_bf16 v[208:211], v[232:235], v[168:171], 0
    ds_read_b64 v[224:225], v248 offset:384
    ds_read_b64 v[226:227], v249 offset:384
    v_mfma_f32_16x16x32_bf16 v[212:215], v[236:239], v[168:171], 0
    v_mfma_f32_16x16x32_bf16 v[216:219], v[232:235], v[172:175], 0
    v_readlane_b32 s36, v240, 10
    v_readlane_b32 s37, v240, 26
    v_mfma_f32_16x16x32_bf16 v[220:223], v[236:239], v[172:175], 0
    v_readlane_b32 s38, v240, 42
    v_readlane_b32 s39, v240, 58
    s_nop 1
    s_set_gpr_idx_on s36, gpr_idx(SRC2,DST)
    v_pk_fma_f32 v[0:1], v[208:209], v[192:193], v[0:1]
    s_mov_b32 m0, s37
    v_pk_fma_f32 v[0:1], v[210:211], v[194:195], v[0:1]
    s_mov_b32 m0, s38
    v_pk_fma_f32 v[0:1], v[212:213], v[196:197], v[0:1]
    s_mov_b32 m0, s39
    v_pk_fma_f32 v[0:1], v[214:215], v[198:199], v[0:1]
    s_lshr_b32 m0, s36, 16
    v_pk_fma_f32 v[0:1], v[216:217], v[200:201], v[0:1]
    s_lshr_b32 m0, s37, 16
    v_pk_fma_f32 v[0:1], v[218:219], v[202:203], v[0:1]
    s_lshr_b32 m0, s38, 16
    v_pk_fma_f32 v[0:1], v[220:221], v[204:205], v[0:1]
    s_lshr_b32 m0, s39, 16
    v_pk_fma_f32 v[0:1], v[222:223], v[206:207], v[0:1]
    s_set_gpr_idx_off
    s_waitcnt lgkmcnt(0)
    v_mfma_f32_32x32x16_bf16 v[192:207], v[224:227], v[228:231], 0
    s_waitcnt vmcnt(2)
    v_mfma_f32_16x16x32_bf16 v[208:211], v[232:235], v[176:179], 0
    ds_read_b64 v[224:225], v248 offset:448
    ds_read_b64 v[226:227], v249 offset:448
    v_mfma_f32_16x16x32_bf16 v[212:215], v[236:239], v[176:179], 0
    v_mfma_f32_16x16x32_bf16 v[216:219], v[232:235], v[180:183], 0
    v_readlane_b32 s36, v240, 12
    v_readlane_b32 s37, v240, 28
    v_mfma_f32_16x16x32_bf16 v[220:223], v[236:239], v[180:183], 0
    v_readlane_b32 s38, v240, 44
    v_readlane_b32 s39, v240, 60
    s_nop 1
    s_set_gpr_idx_on s36, gpr_idx(SRC2,DST)
    v_pk_fma_f32 v[0:1], v[208:209], v[192:193], v[0:1]
    s_mov_b32 m0, s37
    v_pk_fma_f32 v[0:1], v[210:211], v[194:195], v[0:1]
    s_mov_b32 m0, s38
    v_pk_fma_f32 v[0:1], v[212:213], v[196:197], v[0:1]
    s_mov_b32 m0, s39
    v_pk_fma_f32 v[0:1], v[214:215], v[198:199], v[0:1]
    s_lshr_b32 m0, s36, 16
    v_pk_fma_f32 v[0:1], v[216:217], v[200:201], v[0:1]
    s_lshr_b32 m0, s37, 16
    v_pk_fma_f32 v[0:1], v[218:219], v[202:203], v[0:1]
    s_lshr_b32 m0, s38, 16
    v_pk_fma_f32 v[0:1], v[220:221], v[204:205], v[0:1]
    s_lshr_b32 m0, s39, 16
    v_pk_fma_f32 v[0:1], v[222:223], v[206:207], v[0:1]
    s_set_gpr_idx_off
    s_waitcnt lgkmcnt(0)
    v_mfma_f32_32x32x16_bf16 v[192:207], v[224:227], v[228:231], 0
    s_waitcnt vmcnt(0)
    v_mfma_f32_16x16x32_bf16 v[208:211], v[232:235], v[184:187], 0
    v_mfma_f32_16x16x32_bf16 v[212:215], v[236:239], v[184:187], 0
    v_mfma_f32_16x16x32_bf16 v[216:219], v[232:235], v[188:191], 0
    v_readlane_b32 s36, v240, 14
    v_readlane_b32 s37, v240, 30
    v_mfma_f32_16x16x32_bf16 v[220:223], v[236:239], v[188:191], 0
    v_readlane_b32 s38, v240, 46
    v_readlane_b32 s39, v240, 62
    s_nop 1
    s_set_gpr_idx_on s36, gpr_idx(SRC2,DST)
    v_pk_fma_f32 v[0:1], v[208:209], v[192:193], v[0:1]
    s_mov_b32 m0, s37
    v_pk_fma_f32 v[0:1], v[210:211], v[194:195], v[0:1]
    s_mov_b32 m0, s38
    v_pk_fma_f32 v[0:1], v[212:213], v[196:197], v[0:1]
    s_mov_b32 m0, s39
    v_pk_fma_f32 v[0:1], v[214:215], v[198:199], v[0:1]
    s_lshr_b32 m0, s36, 16
    v_pk_fma_f32 v[0:1], v[216:217], v[200:201], v[0:1]
    s_lshr_b32 m0, s37, 16
    v_pk_fma_f32 v[0:1], v[218:219], v[202:203], v[0:1]
    s_lshr_b32 m0, s38, 16
    v_pk_fma_f32 v[0:1], v[220:221], v[204:205], v[0:1]
    s_lshr_b32 m0, s39, 16
    v_pk_fma_f32 v[0:1], v[222:223], v[206:207], v[0:1]
    s_set_gpr_idx_off
LM_drained:
    v_lshrrev_b32 v254, 4, v247
    s_waitcnt lgkmcnt(0)
    s_cmp_eq_u32 s35, 0
    s_cbranch_scc1 LM_out
    s_add_u32 s101, s101, 1536
    s_cmp_lt_u32 s101, s100
    s_cbranch_scc1 LM_round
LM_out:
    v_cvt_pk_bf16_f32 v208, v0, v1
    v_cvt_pk_bf16_f32 v209, v2, v3
    v_cvt_pk_bf16_f32 v210, v4, v5
    v_cvt_pk_bf16_f32 v211, v6, v7
    v_cvt_pk_bf16_f32 v212, v8, v9
    v_cvt_pk_bf16_f32 v213, v10, v11
    v_cvt_pk_bf16_f32 v214, v12, v13
    v_cvt_pk_bf16_f32 v215, v14, v15
    v_cvt_pk_bf16_f32 v216, v16, v17
    v_cvt_pk_bf16_f32 v217, v18, v19
    v_cvt_pk_bf16_f32 v218, v20, v21
    v_cvt_pk_bf16_f32 v219, v22, v23
    v_cvt_pk_bf16_f32 v220, v24, v25
    v_cvt_pk_bf16_f32 v221, v26, v27
    v_cvt_pk_bf16_f32 v222, v28, v29
    v_cvt_pk_bf16_f32 v223, v30, v31
    v_permlane16_swap_b32 v208, v209
    v_permlane16_swap_b32 v210, v211
    v_permlane16_swap_b32 v212, v213
    v_permlane16_swap_b32 v214, v215
    v_permlane16_swap_b32 v216, v217
    v_permlane16_swap_b32 v218, v219
    v_permlane16_swap_b32 v220, v221
    v_permlane16_swap_b32 v222, v223
    v_permlane32_swap_b32 v208, v210
    v_permlane32_swap_b32 v209, v211
    buffer_store_dwordx4 v[208:211], v247, s[12:15], s55 offen sc1
    s_add_u32 s55, s55, 2097152
    v_permlane32_swap_b32 v212, v214
    v_permlane32_swap_b32 v213, v215
    buffer_store_dwordx4 v[212:215], v247, s[12:15], s55 offen sc1
    s_add_u32 s55, s55, 2097152
    v_permlane32_swap_b32 v216, v218
    v_permlane32_swap_b32 v217, v219
    buffer_store_dwordx4 v[216:219], v247, s[12:15], s55 offen sc1
    s_add_u32 s55, s55, 2097152
    v_permlane32_swap_b32 v220, v222
    v_permlane32_swap_b32 v221, v223
    buffer_store_dwordx4 v[220:223], v247, s[12:15], s55 offen sc1
    s_add_u32 s55, s55, 2097152
    v_cvt_pk_bf16_f32 v160, v32, v33
    v_cvt_pk_bf16_f32 v161, v34, v35
    v_cvt_pk_bf16_f32 v162, v36, v37
    v_cvt_pk_bf16_f32 v163, v38, v39
    v_cvt_pk_bf16_f32 v164, v40, v41
    v_cvt_pk_bf16_f32 v165, v42, v43
    v_cvt_pk_bf16_f32 v166, v44, v45
    v_cvt_pk_bf16_f32 v167, v46, v47
    v_cvt_pk_bf16_f32 v168, v48, v49
    v_cvt_pk_bf16_f32 v169, v50, v51
    v_cvt_pk_bf16_f32 v170, v52, v53
    v_cvt_pk_bf16_f32 v171, v54, v55
    v_cvt_pk_bf16_f32 v172, v56, v57
    v_cvt_pk_bf16_f32 v173, v58, v59
    v_cvt_pk_bf16_f32 v174, v60, v61
    v_cvt_pk_bf16_f32 v175, v62, v63
    v_permlane16_swap_b32 v160, v161
    v_permlane16_swap_b32 v162, v163
    v_permlane16_swap_b32 v164, v165
    v_permlane16_swap_b32 v166, v167
    v_permlane16_swap_b32 v168, v169
    v_permlane16_swap_b32 v170, v171
    v_permlane16_swap_b32 v172, v173
    v_permlane16_swap_b32 v174, v175
    v_permlane32_swap_b32 v160, v162
    v_permlane32_swap_b32 v161, v163
    buffer_store_dwordx4 v[160:163], v247, s[12:15], s55 offen sc1
    s_add_u32 s55, s55, 2097152
    v_permlane32_swap_b32 v164, v166
    v_permlane32_swap_b32 v165, v167
    buffer_store_dwordx4 v[164:167], v247, s[12:15], s55 offen sc1
    s_add_u32 s55, s55, 2097152
    v_permlane32_swap_b32 v168, v170
    v_permlane32_swap_b32 v169, v171
    buffer_store_dwordx4 v[168:171], v247, s[12:15], s55 offen sc1
    s_add_u32 s55, s55, 2097152
    v_permlane32_swap_b32 v172, v174
    v_permlane32_swap_b32 v173, v175
    buffer_store_dwordx4 v[172:175], v247, s[12:15], s55 offen sc1
    s_add_u32 s55, s55, 2097152
    v_cvt_pk_bf16_f32 v176, v64, v65
    v_cvt_pk_bf16_f32 v177, v66, v67
    v_cvt_pk_bf16_f32 v178, v68, v69
    v_cvt_pk_bf16_f32 v179, v70, v71
    v_cvt_pk_bf16_f32 v180, v72, v73
    v_cvt_pk_bf16_f32 v181, v74, v75
    v_cvt_pk_bf16_f32 v182, v76, v77
    v_cvt_pk_bf16_f32 v183, v78, v79
    v_cvt_pk_bf16_f32 v184, v80, v81
    v_cvt_pk_bf16_f32 v185, v82, v83
    v_cvt_pk_bf16_f32 v186, v84, v85
    v_cvt_pk_bf16_f32 v187, v86, v87
    v_cvt_pk_bf16_f32 v188, v88, v89
    v_cvt_pk_bf16_f32 v189, v90, v91
    v_cvt_pk_bf16_f32 v190, v92, v93
    v_cvt_pk_bf16_f32 v191, v94, v95
    v_permlane16_swap_b32 v176, v177
    v_permlane16_swap_b32 v178, v179
    v_permlane16_swap_b32 v180, v181
    v_permlane16_swap_b32 v182, v183
    v_permlane16_swap_b32 v184, v185
    v_permlane16_swap_b32 v186, v187
    v_permlane16_swap_b32 v188, v189
    v_permlane16_swap_b32 v190, v191
    v_permlane32_swap_b32 v176, v178
    v_permlane32_swap_b32 v177, v179
    buffer_store_dwordx4 v[176:179], v247, s[12:15], s55 offen sc1
    s_add_u32 s55, s55, 2097152
    v_permlane32_swap_b32 v180, v182
    v_permlane32_swap_b32 v181, v183
    buffer_store_dwordx4 v[180:183], v247, s[12:15], s55 offen sc1
    s_add_u32 s55, s55, 2097152
    v_permlane32_swap_b32 v184, v186
    v_permlane32_swap_b32 v185, v187
    buffer_store_dwordx4 v[184:187], v247, s[12:15], s55 offen sc1
    s_add_u32 s55, s55, 2097152
    v_permlane32_swap_b32 v188, v190
    v_permlane32_swap_b32 v189, v191
    buffer_store_dwordx4 v[188:191], v247, s[12:15], s55 offen sc1
    s_add_u32 s55, s55, 2097152
    v_cvt_pk_bf16_f32 v208, v96, v97
    v_cvt_pk_bf16_f32 v209, v98, v99
    v_cvt_pk_bf16_f32 v210, v100, v101
    v_cvt_pk_bf16_f32 v211, v102, v103
    v_cvt_pk_bf16_f32 v212, v104, v105
    v_cvt_pk_bf16_f32 v213, v106, v107
    v_cvt_pk_bf16_f32 v214, v108, v109
    v_cvt_pk_bf16_f32 v215, v110, v111
    v_cvt_pk_bf16_f32 v216, v112, v113
    v_cvt_pk_bf16_f32 v217, v114, v115
    v_cvt_pk_bf16_f32 v218, v116, v117
    v_cvt_pk_bf16_f32 v219, v118, v119
    v_cvt_pk_bf16_f32 v220, v120, v121
    v_cvt_pk_bf16_f32 v221, v122, v123
    v_cvt_pk_bf16_f32 v222, v124, v125
    v_cvt_pk_bf16_f32 v223, v126, v127
    v_permlane16_swap_b32 v208, v209
    v_permlane16_swap_b32 v210, v211
    v_permlane16_swap_b32 v212, v213
    v_permlane16_swap_b32 v214, v215
    v_permlane16_swap_b32 v216, v217
    v_permlane16_swap_b32 v218, v219
    v_permlane16_swap_b32 v220, v221
    v_permlane16_swap_b32 v222, v223
    v_permlane32_swap_b32 v208, v210
    v_permlane32_swap_b32 v209, v211
    buffer_store_dwordx4 v[208:211], v247, s[12:15], s55 offen sc1
    s_add_u32 s55, s55, 2097152
    v_permlane32_swap_b32 v212, v214
    v_permlane32_swap_b32 v213, v215
    buffer_store_dwordx4 v[212:215], v247, s[12:15], s55 offen sc1
    s_add_u32 s55, s55, 2097152
    v_permlane32_swap_b32 v216, v218
    v_permlane32_swap_b32 v217, v219
    buffer_store_dwordx4 v[216:219], v247, s[12:15], s55 offen sc1
    s_add_u32 s55, s55, 2097152
    v_permlane32_swap_b32 v220, v222
    v_permlane32_swap_b32 v221, v223
    buffer_store_dwordx4 v[220:223], v247, s[12:15], s55 offen sc1
    s_add_u32 s55, s55, 2097152
    v_cvt_pk_bf16_f32 v160, v128, v129
    v_cvt_pk_bf16_f32 v161, v130, v131
    v_cvt_pk_bf16_f32 v162, v132, v133
    v_cvt_pk_bf16_f32 v163, v134, v135
    v_cvt_pk_bf16_f32 v164, v136, v137
    v_cvt_pk_bf16_f32 v165, v138, v139
    v_cvt_pk_bf16_f32 v166, v140, v141
    v_cvt_pk_bf16_f32 v167, v142, v143
    v_cvt_pk_bf16_f32 v168, v144, v145
    v_cvt_pk_bf16_f32 v169, v146, v147
    v_cvt_pk_bf16_f32 v170, v148, v149
    v_cvt_pk_bf16_f32 v171, v150, v151
    v_cvt_pk_bf16_f32 v172, v152, v153
    v_cvt_pk_bf16_f32 v173, v154, v155
    v_cvt_pk_bf16_f32 v174, v156, v157
    v_cvt_pk_bf16_f32 v175, v158, v159
    v_permlane16_swap_b32 v160, v161
    v_permlane16_swap_b32 v162, v163
    v_permlane16_swap_b32 v164, v165
    v_permlane16_swap_b32 v166, v167
    v_permlane16_swap_b32 v168, v169
    v_permlane16_swap_b32 v170, v171
    v_permlane16_swap_b32 v172, v173
    v_permlane16_swap_b32 v174, v175
    v_permlane32_swap_b32 v160, v162
    v_permlane32_swap_b32 v161, v163
    buffer_store_dwordx4 v[160:163], v247, s[12:15], s55 offen sc1
    s_add_u32 s55, s55, 2097152
    v_permlane32_swap_b32 v164, v166
    v_permlane32_swap_b32 v165, v167
    buffer_store_dwordx4 v[164:167], v247, s[12:15], s55 offen sc1
    s_add_u32 s55, s55, 2097152
    v_permlane32_swap_b32 v168, v170
    v_permlane32_swap_b32 v169, v171
    buffer_store_dwordx4 v[168:171], v247, s[12:15], s55 offen sc1
    s_add_u32 s55, s55, 2097152
    s_cmp_ge_u32 s2, 136
    s_cbranch_scc1 LM_stored
    v_permlane32_swap_b32 v172, v174
    v_permlane32_swap_b32 v173, v175
    buffer_store_dwordx4 v[172:175], v247, s[12:15], s55 offen sc1
    s_add_u32 s55, s55, 2097152
LM_stored:
LM_end:
    s_endpgm
LM_slow:
    v_lshrrev_b32 v164, 5, v254
    v_lshrrev_b32 v171, 4, v254
    v_and_b32 v168, 1, v254
    v_cmp_eq_u32 s[4:5], v168, v164
    v_bfe_u32 v169, v254, 2, 1
    v_cmp_eq_u32 vcc, 0, v169
    s_and_b64 s[24:25], s[4:5], vcc
    s_andn2_b64 s[26:27], s[4:5], vcc
    v_bfe_u32 v170, v254, 1, 1
    v_lshlrev_b32 v168, 4, v168
    v_mov_b32 v172, 0x3f80
    v_lshlrev_b32 v168, v168, v172
    v_sub_u32 v172, v171, v170
    v_bfe_u32 v173, v254, 2, 2
    v_lshl_add_u32 v173, v172, 2, v173
    v_cmp_eq_u32 vcc, 0, v173
    s_nop 1
    v_cndmask_b32 v232, 0, v168, vcc
    v_cmp_eq_u32 vcc, 1, v173
    s_nop 1
    v_cndmask_b32 v233, 0, v168, vcc
    v_cmp_eq_u32 vcc, 2, v173
    s_nop 1
    v_cndmask_b32 v234, 0, v168, vcc
    v_cmp_eq_u32 vcc, 3, v173
    s_nop 1
    v_cndmask_b32 v235, 0, v168, vcc
    v_cmp_eq_u32 vcc, 8, v173
    s_nop 1
    v_cndmask_b32 v236, 0, v168, vcc
    v_cmp_eq_u32 vcc, 9, v173
    s_nop 1
    v_cndmask_b32 v237, 0, v168, vcc
    v_cmp_eq_u32 vcc, 10, v173
    s_nop 1
    v_cndmask_b32 v238, 0, v168, vcc
    v_cmp_eq_u32 vcc, 11, v173
    s_nop 1
    v_cndmask_b32 v239, 0, v168, vcc
    s_mov_b32 s35, 1
    s_lshl_b32 s4, s3, 7
    v_and_b32 v160, 7, v254
    v_lshrrev_b32 v161, 4, v254
    v_lshl_add_u32 v160, v160, 2, v161
    v_lshl_add_u32 v160, v160, 2, s4
    ds_write_b32 v160, v255 offset:13376
    v_lshlrev_b32 v161, 4, v254
    s_waitcnt lgkmcnt(0)
    s_barrier
    ds_read_b128 v[164:167], v161 offset:13376
    s_waitcnt lgkmcnt(0)
    v_lshrrev_b32 v168, 16, v164
    v_and_b32 v164, 0xffff, v164
    v_sub_u32 v168, v168, v164
    v_lshrrev_b32 v169, 16, v165
    v_and_b32 v165, 0xffff, v165
    v_sub_u32 v169, v169, v165
    v_lshrrev_b32 v170, 16, v166
    v_and_b32 v166, 0xffff, v166
    v_sub_u32 v170, v170, v166
    v_lshrrev_b32 v171, 16, v167
    v_and_b32 v167, 0xffff, v167
    v_sub_u32 v171, v171, v167
    v_add_u32 v169, v168, v169
    v_add_u32 v170, v169, v170
    v_add_u32 v171, v170, v171
    v_mov_b32 v163, v171
    s_nop 1
    v_add_u32_dpp v163, v163, v163 row_shr:1 row_mask:0xf bank_mask:0xf
    s_nop 1
    v_add_u32_dpp v163, v163, v163 row_shr:2 row_mask:0xf bank_mask:0xf
    s_nop 1
    v_add_u32_dpp v163, v163, v163 row_shr:4 row_mask:0xf bank_mask:0xf
    s_nop 1
    v_add_u32_dpp v163, v163, v163 row_shr:8 row_mask:0xf bank_mask:0xf
    s_nop 1
    v_add_u32_dpp v163, v163, v163 row_bcast:15 row_mask:0xa bank_mask:0xf
    s_nop 1
    v_add_u32_dpp v163, v163, v163 row_bcast:31 row_mask:0xc bank_mask:0xf
    v_sub_u32 v172, v163, v171
    v_readlane_b32 s100, v163, 63
    v_add_u32 v173, v172, v168
    v_add_u32 v174, v172, v169
    v_add_u32 v175, v172, v170
    ds_write_b128 v161, v[172:175] offset:14400
    v_sub_u32 v164, v164, v172
    v_sub_u32 v165, v165, v173
    v_sub_u32 v166, v166, v174
    v_sub_u32 v167, v167, v175
    ds_write_b128 v161, v[164:167] offset:15424
    v_mov_b32 v0, 0
    v_mov_b32 v1, 0
    v_mov_b32 v2, 0
    v_mov_b32 v3, 0
    v_mov_b32 v4, 0
    v_mov_b32 v5, 0
    v_mov_b32 v6, 0
    v_mov_b32 v7, 0
    v_mov_b32 v8, 0
    v_mov_b32 v9, 0
    v_mov_b32 v10, 0
    v_mov_b32 v11, 0
    v_mov_b32 v12, 0
    v_mov_b32 v13, 0
    v_mov_b32 v14, 0
    v_mov_b32 v15, 0
    v_mov_b32 v16, 0
    v_mov_b32 v17, 0
    v_mov_b32 v18, 0
    v_mov_b32 v19, 0
    v_mov_b32 v20, 0
    v_mov_b32 v21, 0
    v_mov_b32 v22, 0
    v_mov_b32 v23, 0
    v_mov_b32 v24, 0
    v_mov_b32 v25, 0
    v_mov_b32 v26, 0
    v_mov_b32 v27, 0
    v_mov_b32 v28, 0
    v_mov_b32 v29, 0
    v_mov_b32 v30, 0
    v_mov_b32 v31, 0
    v_mov_b32 v32, 0
    v_mov_b32 v33, 0
    v_mov_b32 v34, 0
    v_mov_b32 v35, 0
    v_mov_b32 v36, 0
    v_mov_b32 v37, 0
    v_mov_b32 v38, 0
    v_mov_b32 v39, 0
    v_mov_b32 v40, 0
    v_mov_b32 v41, 0
    v_mov_b32 v42, 0
    v_mov_b32 v43, 0
    v_mov_b32 v44, 0
    v_mov_b32 v45, 0
    v_mov_b32 v46, 0
    v_mov_b32 v47, 0
    v_mov_b32 v48, 0
    v_mov_b32 v49, 0
    v_mov_b32 v50, 0
    v_mov_b32 v51, 0
    v_mov_b32 v52, 0
    v_mov_b32 v53, 0
    v_mov_b32 v54, 0
    v_mov_b32 v55, 0
    v_mov_b32 v56, 0
    v_mov_b32 v57, 0
    v_mov_b32 v58, 0
    v_mov_b32 v59, 0
    v_mov_b32 v60, 0
    v_mov_b32 v61, 0
    v_mov_b32 v62, 0
    v_mov_b32 v63, 0
    v_mov_b32 v64, 0
    v_mov_b32 v65, 0
    v_mov_b32 v66, 0
    v_mov_b32 v67, 0
    v_mov_b32 v68, 0
    v_mov_b32 v69, 0
    v_mov_b32 v70, 0
    v_mov_b32 v71, 0
    v_mov_b32 v72, 0
    v_mov_b32 v73, 0
    v_mov_b32 v74, 0
    v_mov_b32 v75, 0
    v_mov_b32 v76, 0
    v_mov_b32 v77, 0
    v_mov_b32 v78, 0
    v_mov_b32 v79, 0
    v_mov_b32 v80, 0
    v_mov_b32 v81, 0
    v_mov_b32 v82, 0
    v_mov_b32 v83, 0
    v_mov_b32 v84, 0
    v_mov_b32 v85, 0
    v_mov_b32 v86, 0
    v_mov_b32 v87, 0
    v_mov_b32 v88, 0
    v_mov_b32 v89, 0
    v_mov_b32 v90, 0
    v_mov_b32 v91, 0
    v_mov_b32 v92, 0
    v_mov_b32 v93, 0
    v_mov_b32 v94, 0
    v_mov_b32 v95, 0
    v_mov_b32 v96, 0
    v_mov_b32 v97, 0
    v_mov_b32 v98, 0
    v_mov_b32 v99, 0
    v_mov_b32 v100, 0
    v_mov_b32 v101, 0
    v_mov_b32 v102, 0
    v_mov_b32 v103, 0
    v_mov_b32 v104, 0
    v_mov_b32 v105, 0
    v_mov_b32 v106, 0
    v_mov_b32 v107, 0
    v_mov_b32 v108, 0
    v_mov_b32 v109, 0
    v_mov_b32 v110, 0
    v_mov_b32 v111, 0
    v_mov_b32 v112, 0
    v_mov_b32 v113, 0
    v_mov_b32 v114, 0
    v_mov_b32 v115, 0
    v_mov_b32 v116, 0
    v_mov_b32 v117, 0
    v_mov_b32 v118, 0
    v_mov_b32 v119, 0
    v_mov_b32 v120, 0
    v_mov_b32 v121, 0
    v_mov_b32 v122, 0
    v_mov_b32 v123, 0
    v_mov_b32 v124, 0
    v_mov_b32 v125, 0
    v_mov_b32 v126, 0
    v_mov_b32 v127, 0
    v_mov_b32 v128, 0
    v_mov_b32 v129, 0
    v_mov_b32 v130, 0
    v_mov_b32 v131, 0
    v_mov_b32 v132, 0
    v_mov_b32 v133, 0
    v_mov_b32 v134, 0
    v_mov_b32 v135, 0
    v_mov_b32 v136, 0
    v_mov_b32 v137, 0
    v_mov_b32 v138, 0
    v_mov_b32 v139, 0
    v_mov_b32 v140, 0
    v_mov_b32 v141, 0
    v_mov_b32 v142, 0
    v_mov_b32 v143, 0
    v_mov_b32 v144, 0
    v_mov_b32 v145, 0
    v_mov_b32 v146, 0
    v_mov_b32 v147, 0
    v_mov_b32 v148, 0
    v_mov_b32 v149, 0
    v_mov_b32 v150, 0
    v_mov_b32 v151, 0
    v_mov_b32 v152, 0
    v_mov_b32 v153, 0
    v_mov_b32 v154, 0
    v_mov_b32 v155, 0
    v_mov_b32 v156, 0
    v_mov_b32 v157, 0
    v_mov_b32 v158, 0
    v_mov_b32 v159, 0
    s_mov_b32 s101, 0
LM_round:
    s_lshl_b32 s4, s3, 6
    v_add_u32 v160, s4, v254
    v_lshlrev_b32 v161, 2, v160
    v_mov_b32 v162, 0
    v_mov_b32 v245, 4
    ds_write_b32 v161, v162 offset:9216
    ds_write_b32 v161, v162 offset:11264
    v_add_u32 v160, s101, v160
    s_mul_i32 s4, s3, 6656
    s_add_u32 s4, s4, 106560
    v_lshl_add_u32 v251, v254, 4, s4
    v_mov_b32 v224, 0x83ffff00
    v_mov_b32 v225, 0x83ffff00
    v_mov_b32 v226, 0x83ffff00
    v_mov_b32 v227, 0x83ffff00
    ds_write_b128 v251, v[224:227] offset:0
    ds_write_b128 v251, v[224:227] offset:1024
    ds_write_b128 v251, v[224:227] offset:2048
    ds_write_b128 v251, v[224:227] offset:3072
    ds_write_b128 v251, v[224:227] offset:4096
    ds_write_b128 v251, v[224:227] offset:5120
    s_mov_b64 exec, 0xffffffff
    s_mov_b32 exec_hi, 0
    ds_write_b128 v251, v[224:227] offset:6144
    s_mov_b64 exec, -1
    s_mul_i32 s4, s3, 3328
    s_add_u32 s4, s4, 79936
    v_lshl_add_u32 v251, v254, 4, s4
    v_mov_b32 v208, 0x0
    v_mov_b32 v209, 0x0
    v_mov_b32 v210, 0x0
    v_mov_b32 v211, 0x0
    ds_write_b128 v251, v[208:211] offset:0
    ds_write_b128 v251, v[208:211] offset:1024
    ds_write_b128 v251, v[208:211] offset:2048
    s_mov_b64 exec, 0xffff
    ds_write_b128 v251, v[208:211] offset:3072
    s_mov_b64 exec, -1
    v_cmp_gt_u32 s[36:37], s100, v160
    v_mov_b32 v163, 0
    ds_read_b32 v164, v163 offset:14912
    v_add_u32 v165, 512, v163
    s_waitcnt lgkmcnt(0)
    v_cmp_le_u32 vcc, v164, v160
    s_nop 1
    v_cndmask_b32 v163, v163, v165, vcc
    ds_read_b32 v164, v163 offset:14656
    v_add_u32 v165, 256, v163
    s_waitcnt lgkmcnt(0)
    v_cmp_le_u32 vcc, v164, v160
    s_nop 1
    v_cndmask_b32 v163, v163, v165, vcc
    ds_read_b32 v164, v163 offset:14528
    v_add_u32 v165, 128, v163
    s_waitcnt lgkmcnt(0)
    v_cmp_le_u32 vcc, v164, v160
    s_nop 1
    v_cndmask_b32 v163, v163, v165, vcc
    ds_read_b32 v164, v163 offset:14464
    v_add_u32 v165, 64, v163
    s_waitcnt lgkmcnt(0)
    v_cmp_le_u32 vcc, v164, v160
    s_nop 1
    v_cndmask_b32 v163, v163, v165, vcc
    ds_read_b32 v164, v163 offset:14432
    v_add_u32 v165, 32, v163
    s_waitcnt lgkmcnt(0)
    v_cmp_le_u32 vcc, v164, v160
    s_nop 1
    v_cndmask_b32 v163, v163, v165, vcc
    ds_read_b32 v164, v163 offset:14416
    v_add_u32 v165, 16, v163
    s_waitcnt lgkmcnt(0)
    v_cmp_le_u32 vcc, v164, v160
    s_nop 1
    v_cndmask_b32 v163, v163, v165, vcc
    ds_read_b32 v164, v163 offset:14408
    v_add_u32 v165, 8, v163
    s_waitcnt lgkmcnt(0)
    v_cmp_le_u32 vcc, v164, v160
    s_nop 1
    v_cndmask_b32 v163, v163, v165, vcc
    ds_read_b32 v164, v163 offset:14404
    v_add_u32 v165, 4, v163
    s_waitcnt lgkmcnt(0)
    v_cmp_le_u32 vcc, v164, v160
    s_nop 1
    v_cndmask_b32 v163, v163, v165, vcc
    ds_read_b32 v164, v163 offset:15424
    v_mul_u32_u24 v163, 15744, v163
    s_waitcnt lgkmcnt(0)
    v_add_u32 v164, v164, v160
    v_lshl_add_u32 v165, v164, 2, v163
    v_lshl_add_u32 v164, v164, 1, v163
    v_add_u32 v164, 41984, v164
    s_mov_b64 exec, s[36:37]
    buffer_load_dword v172, v165, s[16:19], 0 offen
    buffer_load_ushort v177, v164, s[16:19], 0 offen
    s_mov_b64 exec, -1
    v_add_u32 v160, 512, v160
    v_cmp_gt_u32 s[38:39], s100, v160
    v_mov_b32 v163, 0
    ds_read_b32 v164, v163 offset:14912
    v_add_u32 v165, 512, v163
    s_waitcnt lgkmcnt(0)
    v_cmp_le_u32 vcc, v164, v160
    s_nop 1
    v_cndmask_b32 v163, v163, v165, vcc
    ds_read_b32 v164, v163 offset:14656
    v_add_u32 v165, 256, v163
    s_waitcnt lgkmcnt(0)
    v_cmp_le_u32 vcc, v164, v160
    s_nop 1
    v_cndmask_b32 v163, v163, v165, vcc
    ds_read_b32 v164, v163 offset:14528
    v_add_u32 v165, 128, v163
    s_waitcnt lgkmcnt(0)
    v_cmp_le_u32 vcc, v164, v160
    s_nop 1
    v_cndmask_b32 v163, v163, v165, vcc
    ds_read_b32 v164, v163 offset:14464
    v_add_u32 v165, 64, v163
    s_waitcnt lgkmcnt(0)
    v_cmp_le_u32 vcc, v164, v160
    s_nop 1
    v_cndmask_b32 v163, v163, v165, vcc
    ds_read_b32 v164, v163 offset:14432
    v_add_u32 v165, 32, v163
    s_waitcnt lgkmcnt(0)
    v_cmp_le_u32 vcc, v164, v160
    s_nop 1
    v_cndmask_b32 v163, v163, v165, vcc
    ds_read_b32 v164, v163 offset:14416
    v_add_u32 v165, 16, v163
    s_waitcnt lgkmcnt(0)
    v_cmp_le_u32 vcc, v164, v160
    s_nop 1
    v_cndmask_b32 v163, v163, v165, vcc
    ds_read_b32 v164, v163 offset:14408
    v_add_u32 v165, 8, v163
    s_waitcnt lgkmcnt(0)
    v_cmp_le_u32 vcc, v164, v160
    s_nop 1
    v_cndmask_b32 v163, v163, v165, vcc
    ds_read_b32 v164, v163 offset:14404
    v_add_u32 v165, 4, v163
    s_waitcnt lgkmcnt(0)
    v_cmp_le_u32 vcc, v164, v160
    s_nop 1
    v_cndmask_b32 v163, v163, v165, vcc
    ds_read_b32 v164, v163 offset:15424
    v_mul_u32_u24 v163, 15744, v163
    s_waitcnt lgkmcnt(0)
    v_add_u32 v164, v164, v160
    v_lshl_add_u32 v165, v164, 2, v163
    v_lshl_add_u32 v164, v164, 1, v163
    v_add_u32 v164, 41984, v164
    s_mov_b64 exec, s[38:39]
    buffer_load_dword v173, v165, s[16:19], 0 offen
    buffer_load_ushort v178, v164, s[16:19], 0 offen
    s_mov_b64 exec, -1
    v_add_u32 v160, 512, v160
    v_cmp_gt_u32 s[40:41], s100, v160
    v_mov_b32 v163, 0
    ds_read_b32 v164, v163 offset:14912
    v_add_u32 v165, 512, v163
    s_waitcnt lgkmcnt(0)
    v_cmp_le_u32 vcc, v164, v160
    s_nop 1
    v_cndmask_b32 v163, v163, v165, vcc
    ds_read_b32 v164, v163 offset:14656
    v_add_u32 v165, 256, v163
    s_waitcnt lgkmcnt(0)
    v_cmp_le_u32 vcc, v164, v160
    s_nop 1
    v_cndmask_b32 v163, v163, v165, vcc
    ds_read_b32 v164, v163 offset:14528
    v_add_u32 v165, 128, v163
    s_waitcnt lgkmcnt(0)
    v_cmp_le_u32 vcc, v164, v160
    s_nop 1
    v_cndmask_b32 v163, v163, v165, vcc
    ds_read_b32 v164, v163 offset:14464
    v_add_u32 v165, 64, v163
    s_waitcnt lgkmcnt(0)
    v_cmp_le_u32 vcc, v164, v160
    s_nop 1
    v_cndmask_b32 v163, v163, v165, vcc
    ds_read_b32 v164, v163 offset:14432
    v_add_u32 v165, 32, v163
    s_waitcnt lgkmcnt(0)
    v_cmp_le_u32 vcc, v164, v160
    s_nop 1
    v_cndmask_b32 v163, v163, v165, vcc
    ds_read_b32 v164, v163 offset:14416
    v_add_u32 v165, 16, v163
    s_waitcnt lgkmcnt(0)
    v_cmp_le_u32 vcc, v164, v160
    s_nop 1
    v_cndmask_b32 v163, v163, v165, vcc
    ds_read_b32 v164, v163 offset:14408
    v_add_u32 v165, 8, v163
    s_waitcnt lgkmcnt(0)
    v_cmp_le_u32 vcc, v164, v160
    s_nop 1
    v_cndmask_b32 v163, v163, v165, vcc
    ds_read_b32 v164, v163 offset:14404
    v_add_u32 v165, 4, v163
    s_waitcnt lgkmcnt(0)
    v_cmp_le_u32 vcc, v164, v160
    s_nop 1
    v_cndmask_b32 v163, v163, v165, vcc
    ds_read_b32 v164, v163 offset:15424
    v_mul_u32_u24 v163, 15744, v163
    s_waitcnt lgkmcnt(0)
    v_add_u32 v164, v164, v160
    v_lshl_add_u32 v165, v164, 2, v163
    v_lshl_add_u32 v164, v164, 1, v163
    v_add_u32 v164, 41984, v164
    s_mov_b64 exec, s[40:41]
    buffer_load_dword v174, v165, s[16:19], 0 offen
    buffer_load_ushort v179, v164, s[16:19], 0 offen
    s_mov_b64 exec, -1
    v_add_u32 v160, 512, v160
    s_lshl_b32 s33, s2, 5
    s_lshl_b32 s34, s3, 2
    s_add_u32 s33, s33, s34
    s_lshl_b32 s34, s3, 26
    s_or_b32 s34, s34, 0xc0000000
    v_mov_b32 v180, 0
    v_add_u32 v251, 0, v254
    v_lshrrev_b32 v252, 2, v251
    v_mul_u32_u24 v252, 8192, v252
    v_and_b32 v175, 3, v251
    v_add3_u32 v252, v252, v175, s33
    v_lshl_or_b32 v175, v252, 7, v251
    v_lshlrev_b32 v175, 1, v175
    v_or_b32 v175, s34, v175
    v_add_u32 v251, 64, v254
    v_lshrrev_b32 v252, 2, v251
    v_mul_u32_u24 v252, 8192, v252
    v_and_b32 v176, 3, v251
    v_add3_u32 v252, v252, v176, s33
    v_lshl_or_b32 v176, v252, 7, v251
    v_lshlrev_b32 v176, 1, v176
    v_or_b32 v176, s34, v176
    s_cmp_lt_u32 s2, 136
    s_cselect_b32 s34, 16, 12
    s_bfm_b32 s34, s34, 0
    s_cmp_eq_u32 s101, 0
    s_cselect_b64 s[42:43], -1, 0
    s_cselect_b32 s44, s34, 0
    s_mov_b32 s45, 0
    s_waitcnt vmcnt(0) lgkmcnt(0)
    s_barrier
    s_mov_b64 exec, s[36:37]
    v_lshrrev_b32 v181, 17, v172
    v_and_b32 v181, 0xffc, v181
    ds_add_rtn_u32 v186, v181, v245 offset:9216
    s_mov_b64 exec, s[38:39]
    v_lshrrev_b32 v182, 17, v173
    v_and_b32 v182, 0xffc, v182
    ds_add_rtn_u32 v187, v182, v245 offset:9216
    s_mov_b64 exec, s[40:41]
    v_lshrrev_b32 v183, 17, v174
    v_and_b32 v183, 0xffc, v183
    ds_add_rtn_u32 v188, v183, v245 offset:9216
    s_mov_b64 exec, s[42:43]
    v_lshrrev_b32 v184, 17, v175
    v_and_b32 v184, 0xffc, v184
    ds_add_rtn_u32 v189, v184, v245 offset:9216
    s_mov_b64 exec, s[44:45]
    v_lshrrev_b32 v185, 17, v176
    v_and_b32 v185, 0xffc, v185
    ds_add_rtn_u32 v190, v185, v245 offset:9216
    s_mov_b64 exec, -1
    s_waitcnt vmcnt(0) lgkmcnt(0)
    s_barrier
    s_lshl_b32 s4, s3, 9
    v_mov_b32 v167, 127
    v_lshl_add_u32 v164, v254, 1, 0
    v_mov_b32 v160, v164
    v_subrev_u32 v166, 79, v160
    v_cmp_gt_u32 vcc, 79, v164
    v_min_u32 v160, v160, v166
    s_nop 0
    v_cndmask_b32 v160, v167, v160, vcc
    v_lshl_add_u32 v160, v160, 2, s4
    ds_read_b32 v162, v160 offset:9216
    v_lshl_add_u32 v165, v254, 1, 1
    v_mov_b32 v161, v165
    v_subrev_u32 v166, 79, v161
    v_cmp_gt_u32 vcc, 79, v165
    v_min_u32 v161, v161, v166
    s_nop 0
    v_cndmask_b32 v161, v167, v161, vcc
    v_lshl_add_u32 v161, v161, 2, s4
    ds_read_b32 v163, v161 offset:9216
    s_mul_i32 s5, s3, 6656
    s_add_u32 s5, s5, 49152
    s_waitcnt lgkmcnt(0)
    v_add_u32 v163, v162, v163
    v_mov_b32 v166, v163
    s_nop 1
    v_add_u32_dpp v166, v166, v166 row_shr:1 row_mask:0xf bank_mask:0xf
    s_nop 1
    v_add_u32_dpp v166, v166, v166 row_shr:2 row_mask:0xf bank_mask:0xf
    s_nop 1
    v_add_u32_dpp v166, v166, v166 row_shr:4 row_mask:0xf bank_mask:0xf
    s_nop 1
    v_add_u32_dpp v166, v166, v166 row_shr:8 row_mask:0xf bank_mask:0xf
    s_nop 1
    v_add_u32_dpp v166, v166, v166 row_bcast:15 row_mask:0xa bank_mask:0xf
    s_nop 1
    v_add_u32_dpp v166, v166, v166 row_bcast:31 row_mask:0xc bank_mask:0xf
    v_sub_u32 v163, v166, v163
    v_readlane_b32 s29, v166, 63
    v_add_u32 v163, s5, v163
    v_add_u32 v162, v163, v162
    s_lshr_b32 s29, s29, 2
    s_mov_b32 s6, s29
    ds_write_b32 v160, v163 offset:9216
    ds_write_b32 v161, v162 offset:9216
    s_lshl_b32 s4, s3, 2
    v_mov_b32 v164, s4
    v_mov_b32 v165, s6
    ds_write_b32 v164, v165 offset:13312
    v_mov_b32 v166, 0
    s_waitcnt lgkmcnt(0)
    s_barrier
    ds_read_b128 v[160:163], v166 offset:13312
    ds_read_b128 v[168:171], v166 offset:13328
    s_waitcnt lgkmcnt(0)
    v_max3_u32 v160, v160, v161, v162
    v_max3_u32 v163, v163, v168, v169
    v_max3_u32 v160, v160, v170, v171
    v_max_u32 v160, v160, v163
    s_nop 0
    v_readfirstlane_b32 s28, v160
    s_mov_b64 exec, s[36:37]
    ds_read_b32 v181, v181 offset:9216
    s_mov_b64 exec, s[38:39]
    ds_read_b32 v182, v182 offset:9216
    s_mov_b64 exec, s[40:41]
    ds_read_b32 v183, v183 offset:9216
    s_mov_b64 exec, s[42:43]
    ds_read_b32 v184, v184 offset:9216
    s_mov_b64 exec, s[44:45]
    ds_read_b32 v185, v185 offset:9216
    s_mov_b64 exec, s[36:37]
    s_waitcnt lgkmcnt(4)
    v_add_u32 v181, v181, v186
    ds_write_b32 v181, v172 offset:57408
    v_lshrrev_b32 v186, 1, v181
    ds_write_b16 v186, v177 offset:55360
    s_mov_b64 exec, s[38:39]
    s_waitcnt lgkmcnt(5)
    v_add_u32 v182, v182, v187
    ds_write_b32 v182, v173 offset:57408
    v_lshrrev_b32 v187, 1, v182
    ds_write_b16 v187, v178 offset:55360
    s_mov_b64 exec, s[40:41]
    s_waitcnt lgkmcnt(6)
    v_add_u32 v183, v183, v188
    ds_write_b32 v183, v174 offset:57408
    v_lshrrev_b32 v188, 1, v183
    ds_write_b16 v188, v179 offset:55360
    s_mov_b64 exec, s[42:43]
    s_waitcnt lgkmcnt(7)
    v_add_u32 v184, v184, v189
    ds_write_b32 v184, v175 offset:57408
    v_lshrrev_b32 v189, 1, v184
    ds_write_b16 v189, v180 offset:55360
    s_mov_b64 exec, s[44:45]
    s_waitcnt lgkmcnt(8)
    v_add_u32 v185, v185, v190
    ds_write_b32 v185, v176 offset:57408
    v_lshrrev_b32 v190, 1, v185
    ds_write_b16 v190, v180 offset:55360
    s_mov_b64 exec, -1
    s_branch LM_tail
.section .rodata,"a"
.p2align 6
.amdhsa_kernel dn_part_kernel
  .amdhsa_next_free_vgpr 104
  .amdhsa_next_free_sgpr 102
  .amdhsa_accum_offset 104
  .amdhsa_group_segment_fixed_size 0
  .amdhsa_kernarg_size 96
  .amdhsa_user_sgpr_count 2
  .amdhsa_user_sgpr_kernarg_segment_ptr 1
  .amdhsa_system_sgpr_workgroup_id_x 1
  .amdhsa_float_denorm_mode_32 3
.end_amdhsa_kernel
.p2align 6
.amdhsa_kernel standalone__molecular_angular_dimenet__graph_kernel
  .amdhsa_next_free_vgpr 256
  .amdhsa_next_free_sgpr 102
  .amdhsa_accum_offset 256
  .amdhsa_group_segment_fixed_size 0
  .amdhsa_kernarg_size 96
  .amdhsa_user_sgpr_count 2
  .amdhsa_user_sgpr_kernarg_segment_ptr 1
  .amdhsa_system_sgpr_workgroup_id_x 1
  .amdhsa_float_denorm_mode_32 3
.end_amdhsa_kernel
```
